```python
import torch

def _softmax(x, axis=-1):
    return torch.softmax(x, dim=axis)
def _gelu(x):
    return torch.nn.functional.gelu(x, approximate="tanh")
def _silu(x):
    return torch.nn.functional.silu(x)
def _sigmoid(x):
    return torch.sigmoid(x)
def _layernorm(x, axis=-1, eps=1e-5):
    m = x.mean(dim=axis, keepdim=True)
    v = x.var(dim=axis, keepdim=True, unbiased=False)
    return (x - m) / torch.sqrt(v + eps)
def _scatter_add(tgt, idx, src, axis=0):
    return tgt.clone().index_add_(axis, idx, src)
def _segment_sum(src, seg, n):
    out = torch.zeros((n,) + src.shape[1:], dtype=src.dtype)
    return out.index_add_(0, seg, src)
def _pad(x, pw):
    flat = tuple(v for pair in reversed(pw) for v in pair)
    return torch.nn.functional.pad(x, flat)

kernel_name = 'sequential_preLN__ssm_conv_s4d__glu_gated_reglu__prompt'

def setup_inputs():

    _w = (lambda a: (lambda t: t.to(torch.bfloat16) if t.is_floating_point() else t)(torch.as_tensor(a)))
    def _A_setup():
        Bsz, L, D, N = 1, 2048, 512, 128
        return {
            "u": _w((lambda *s: torch.randn(*s, dtype=torch.bfloat16) * 0.05)(Bsz, L, D)),
            "log_A_real": _w((lambda *s: torch.randn(*s, dtype=torch.bfloat16) * 6.4)(D, N) * 0.5),
            "A_imag": _w((lambda *s: torch.randn(*s, dtype=torch.bfloat16) * 0.05)(D, N) * 3.14),
            "C_real": _w((lambda *s: torch.randn(*s, dtype=torch.bfloat16) * 0.05)(D, N) / N ** 0.5),
            "C_imag": _w((lambda *s: torch.randn(*s, dtype=torch.bfloat16) * 0.05)(D, N) / N ** 0.5),
            "log_dt": _w((lambda *s: torch.randn(*s, dtype=torch.bfloat16) * 0.05)(D) * 0.5 - 4.0),
            "D_skip": _w((lambda *s: torch.randn(*s, dtype=torch.bfloat16) * 0.05)(D)),
        }
    _A_in = _A_setup()

    def _B_setup():
        B, S, D, F = 1, 2048, 512, 1376
        return {
            "x": _w((lambda *s: torch.randn(*s, dtype=torch.bfloat16) * 0.05)(B, S, D)),
            "W_gate": _w((lambda *s: torch.randn(*s, dtype=torch.bfloat16) * 0.4)(D, F) * (2.0 / D) ** 0.5),
            "W_up": _w((lambda *s: torch.randn(*s, dtype=torch.bfloat16) * 0.4)(D, F) * (2.0 / D) ** 0.5),
            "W_down": _w((lambda *s: torch.randn(*s, dtype=torch.bfloat16) * 0.4)(F, D) * (1.0 / F) ** 0.5),
        }
    _B_in = _B_setup()

    return {
        "A_u": _A_in["u"],
        "A_log_A_real": _A_in["log_A_real"],
        "A_A_imag": _A_in["A_imag"],
        "A_C_real": _A_in["C_real"],
        "A_C_imag": _A_in["C_imag"],
        "A_log_dt": _A_in["log_dt"],
        "A_D_skip": _A_in["D_skip"],
        "B_x": _B_in["x"],
        "B_W_gate": _B_in["W_gate"],
        "B_W_up": _B_in["W_up"],
        "B_W_down": _B_in["W_down"],
    }

def reference(A_u, A_log_A_real, A_A_imag, A_C_real, A_C_imag, A_log_dt, A_D_skip, B_x, B_W_gate, B_W_up, B_W_down):
    def _A_ref(u, log_A_real, A_imag, C_real, C_imag, log_dt, D_skip):
        L = u.shape[1]
        dt = torch.exp(log_dt)
        A = -torch.exp(log_A_real) + 1j * A_imag
        C = (C_real + 1j * C_imag) * dt[:, None]
        pos = (lambda x, dt: x.to(dt))(torch.arange(L), log_dt.dtype)
        P = torch.exp((A * dt[:, None])[:, :, None] * pos[None, None, :])
        K = 2.0 * torch.einsum("dn,dnl->dl", C, P).real
        L2 = 2 * L
        u_t = (lambda x, *d: x.permute(*d))(u, 0, 2, 1)
        Kf = (lambda x, *a, **k: torch.fft.rfft(x.float(), *a, **k))(K, L2)
        Uf = (lambda x, *a, **k: torch.fft.rfft(x.float(), *a, **k))(u_t, L2)
        y = (lambda x, *a, **k: torch.fft.irfft(x, *a, **k).to(torch.bfloat16))(Uf * Kf[None, :, :], L2)[:, :, :L]
        y = (lambda x, *d: x.permute(*d))(y, 0, 2, 1)
        return y + u * D_skip[None, None, :]

    def _B_ref(x, W_gate, W_up, W_down):
        gate = torch.einsum("bsd,df->bsf", x, W_gate)
        up = torch.einsum("bsd,df->bsf", x, W_up)
        gate = gate * (lambda x, dt: x.to(dt))(gate > 0, gate.dtype)
        h = gate * up
        return torch.einsum("bsf,fd->bsd", h, W_down)

    x = A_u
    h = x + _A_ref(_layernorm(x, axis=-1), A_log_A_real, A_A_imag, A_C_real, A_C_imag, A_log_dt, A_D_skip)
    h2 = h + _B_ref(_layernorm(h, axis=-1), B_W_gate, B_W_up, B_W_down)
    return h2
```

```asm
; @launch grid=(256,1,1) block=(512,1,1) lds=161536
.amdgcn_target "amdgcn-amd-amdhsa--gfx950"
.text
.globl sequential_preLN__ssm_conv_s4d__glu_gated_reglu__prompt_kernel
.p2align 8
.type sequential_preLN__ssm_conv_s4d__glu_gated_reglu__prompt_kernel,@function
sequential_preLN__ssm_conv_s4d__glu_gated_reglu__prompt_kernel:

  s_load_dwordx16 s[16:31], s[0:1], 0x0
  s_load_dwordx8 s[32:39], s[0:1], 0x40
  s_load_dwordx4 s[40:43], s[0:1], 0x60
  s_cmp_ge_u32 s2, 256
  s_cbranch_scc1 KEND
  v_and_b32 v1, 63, v0
  v_lshrrev_b32 v2, 6, v0
  s_nop 0
  v_readfirstlane_b32 s3, v2
  s_waitcnt lgkmcnt(0)
  s_mov_b32 s72, s40
  s_and_b32 s73, s41, 0xffff
  s_mov_b32 s74, 0x00000100
  s_mov_b32 s75, 0x00020000
  s_lshl_b32 s76, s2, 3
  s_add_u32 s76, s76, s3
  s_cmp_lg_u32 s76, 5
  s_cbranch_scc1 NONONCE
  s_memrealtime s[76:77]
  s_waitcnt lgkmcnt(0)
  s_lshl_b32 s76, s76, 6
  s_or_b32 s76, s76, 0x40000000
  v_mov_b32 v5, s76
  v_mov_b32 v6, 0
  s_mov_b64 exec, 1
  buffer_store_dword v5, v6, s[72:75], 0 offen sc0 sc1
  s_mov_b64 exec, -1
NONONCE:
  s_mov_b32 s64, s16
  s_and_b32 s65, s17, 0xffff
  s_mov_b32 s66, 0x00200000
  s_mov_b32 s67, 0x00020000
  s_lshl_b32 s76, s2, 13
  s_lshl_b32 s77, s3, 10
  s_add_u32 s76, s76, s77
  v_lshlrev_b32 v20, 4, v1
  buffer_load_dwordx4 v[24:27], v20, s[64:67], s76 offen
  v_lshrrev_b32 v21, 4, v0
  v_lshlrev_b32 v21, 10, v21
  v_and_b32 v22, 15, v0
  v_lshl_add_u32 v21, v22, 4, v21
  s_lshr_b32 s76, s2, 2
  s_lshl_b32 s76, s76, 15
  s_and_b32 s77, s2, 3
  s_lshl_b32 s77, s77, 8
  s_add_u32 s76, s76, s77
  buffer_load_dwordx4 v[108:111], v21, s[64:67], s76 offen
  s_mov_b32 s44, s18
  s_and_b32 s45, s19, 0xffff
  s_mov_b32 s46, 0x00020000
  s_mov_b32 s47, 0x00020000
  s_mov_b32 s48, s20
  s_and_b32 s49, s21, 0xffff
  s_mov_b32 s50, 0x00020000
  s_mov_b32 s51, 0x00020000
  s_mov_b32 s52, s22
  s_and_b32 s53, s23, 0xffff
  s_mov_b32 s54, 0x00020000
  s_mov_b32 s55, 0x00020000
  s_mov_b32 s56, s24
  s_and_b32 s57, s25, 0xffff
  s_mov_b32 s58, 0x00020000
  s_mov_b32 s59, 0x00020000
  s_mov_b32 s60, s26
  s_and_b32 s61, s27, 0xffff
  s_mov_b32 s62, 0x00000400
  s_mov_b32 s63, 0x00020000
  s_lshr_b32 s4, s3, 2
  s_lshl_b32 s5, s2, 1
  s_add_u32 s5, s5, s4
  s_lshl_b32 s76, s5, 8
  s_lshl_b32 s77, s5, 1
  v_and_b32 v3, 127, v0
  v_lshlrev_b32 v5, 1, v3
  v_lshlrev_b32 v6, 2, v1
  v_mov_b32 v7, s77
  buffer_load_ushort v10, v5, s[44:47], s76 offen
  buffer_load_ushort v11, v5, s[48:51], s76 offen
  buffer_load_ushort v12, v5, s[52:55], s76 offen
  buffer_load_ushort v13, v5, s[56:59], s76 offen
  buffer_load_dword v14, v6, s[52:55], s76 offen
  buffer_load_dword v15, v6, s[56:59], s76 offen
  buffer_load_ushort v16, v7, s[60:63], 0 offen
  s_mov_b32 s80, 0x3f803f80
  s_mov_b32 s81, 0x00003f80
  s_mov_b32 s82, 0x3f800000
  s_cmp_ge_u32 s3, 6
  s_cbranch_scc1 JL_WD
  s_cmp_ge_u32 s3, 3
  s_cselect_b32 s70, 1, 0
  s_cselect_b32 s44, s34, s32
  s_cselect_b32 s45, s35, s33
  s_and_b32 s45, s45, 0xffff
  s_mov_b32 s46, 1409024
  s_mov_b32 s47, 0x00020000
  s_mul_i32 s71, s70, 3
  s_sub_u32 s71, s3, s71
  s_mul_i32 s76, s71, 14
  s_min_u32 s77, s71, 1
  s_add_u32 s76, s76, s77
  s_add_u32 s77, s76, 13
  s_cmp_eq_u32 s71, 0
  s_cselect_b32 s77, 14, s77
  v_add_u32 v17, s76, v1
  v_min_u32 v17, s77, v17
  s_and_b32 s76, s2, 3
  s_mul_i32 s76, s76, 43
  v_add_u32 v18, s76, v17
  s_lshr_b32 s77, s2, 2
  v_lshlrev_b32 v23, 4, v18
  s_mul_i32 s76, s77, 22016
  buffer_load_dwordx4 v[32:35], v23, s[44:47], s76 offen
  s_add_u32 s76, s76, 2752
  buffer_load_dwordx4 v[36:39], v23, s[44:47], s76 offen
  s_add_u32 s76, s76, 2752
  buffer_load_dwordx4 v[40:43], v23, s[44:47], s76 offen
  s_add_u32 s76, s76, 2752
  buffer_load_dwordx4 v[44:47], v23, s[44:47], s76 offen
  s_add_u32 s76, s76, 2752
  buffer_load_dwordx4 v[48:51], v23, s[44:47], s76 offen
  s_add_u32 s76, s76, 2752
  buffer_load_dwordx4 v[52:55], v23, s[44:47], s76 offen
  s_add_u32 s76, s76, 2752
  buffer_load_dwordx4 v[56:59], v23, s[44:47], s76 offen
  s_add_u32 s76, s76, 2752
  buffer_load_dwordx4 v[60:63], v23, s[44:47], s76 offen
  v_mul_u32_u24 v19, 16640, v18
  s_lshl_b32 s77, s77, 8
  v_add_u32 v19, s77, v19
  v_mul_u32_u24 v18, 272, v17
  s_lshl_b32 s77, s70, 4
  s_add_u32 s77, s77, 117248
  v_add_u32 v18, s77, v18
  s_mov_b32 s70, 32
  s_branch JL_DONE
JL_WD:
  s_mov_b32 s44, s36
  s_and_b32 s45, s37, 0xffff
  s_mov_b32 s46, 0x00158000
  s_mov_b32 s47, 0x00020000
  s_sub_u32 s71, s3, 6
  s_mul_i32 s76, s71, 22
  s_add_u32 s77, s76, 20
  s_cmp_eq_u32 s71, 0
  s_cselect_b32 s77, 21, s77
  v_add_u32 v17, s76, v1
  v_min_u32 v17, s77, v17
  s_mul_i32 s76, s2, 43
  v_add_u32 v18, s76, v17
  v_lshrrev_b32 v19, 6, v18
  v_and_b32 v18, 63, v18
  v_lshlrev_b32 v23, 13, v19
  v_lshl_add_u32 v23, v18, 4, v23
  s_movk_i32 s76, 0x1000
  buffer_load_dwordx4 v[32:35], v23, s[44:47], 0 offen offset:0
  buffer_load_dwordx4 v[36:39], v23, s[44:47], 0 offen offset:1024
  buffer_load_dwordx4 v[40:43], v23, s[44:47], 0 offen offset:2048
  buffer_load_dwordx4 v[44:47], v23, s[44:47], 0 offen offset:3072
  buffer_load_dwordx4 v[48:51], v23, s[44:47], s76 offen offset:0
  buffer_load_dwordx4 v[52:55], v23, s[44:47], s76 offen offset:1024
  buffer_load_dwordx4 v[56:59], v23, s[44:47], s76 offen offset:2048
  buffer_load_dwordx4 v[60:63], v23, s[44:47], s76 offen offset:3072
  v_lshlrev_b32 v19, 8, v19
  v_lshrrev_b32 v23, 1, v18
  v_mul_u32_u24 v23, 44032, v23
  v_add_u32 v19, v19, v23
  v_and_b32 v18, 1, v18
  v_lshl_add_u32 v19, v18, 7, v19
  v_mul_u32_u24 v18, 144, v17
  v_add_u32 v18, 128944, v18
  s_mov_b32 s70, 16
JL_DONE:
  s_mov_b32 s78, 0x05040100
  s_mov_b32 s79, 0x07060302
  s_waitcnt vmcnt(15)
  v_and_b32 v21, 15, v0
  v_mul_u32_u24 v21, 576, v21
  v_lshrrev_b32 v22, 4, v0
  v_lshl_add_u32 v21, v22, 2, v21
  v_add_u32 v21, 152064, v21
  ds_write_b32 v21, v108 offset:0
  ds_write_b32 v21, v109 offset:144
  ds_write_b32 v21, v110 offset:288
  ds_write_b32 v21, v111 offset:432
  v_dot2_f32_bf16 v28, v24, s80, 0
  v_dot2_f32_bf16 v28, v25, s80, v28
  v_dot2_f32_bf16 v28, v26, s80, v28
  v_dot2_f32_bf16 v28, v27, s80, v28
  s_nop 2
  v_add_f32_dpp v28, v28, v28 quad_perm:[1,0,3,2] row_mask:0xf bank_mask:0xf
  s_nop 1
  v_add_f32_dpp v28, v28, v28 quad_perm:[2,3,0,1] row_mask:0xf bank_mask:0xf
  s_nop 1
  v_add_f32_dpp v28, v28, v28 row_half_mirror row_mask:0xf bank_mask:0xf
  s_nop 1
  v_add_f32_dpp v28, v28, v28 row_mirror row_mask:0xf bank_mask:0xf
  v_mov_b32 v29, v28
  s_nop 1
  v_permlane16_swap_b32 v28, v29
  v_add_f32 v28, v28, v29
  v_mov_b32 v29, v28
  s_nop 1
  v_permlane32_swap_b32 v28, v29
  v_add_f32 v28, v28, v29
  v_mul_f32 v28, 0xbb000000, v28
  v_dot2_f32_bf16 v100, v24, s81, v28
  v_dot2_f32_bf16 v101, v24, s82, v28
  v_dot2_f32_bf16 v102, v25, s81, v28
  v_dot2_f32_bf16 v103, v25, s82, v28
  v_dot2_f32_bf16 v104, v26, s81, v28
  v_dot2_f32_bf16 v105, v26, s82, v28
  v_dot2_f32_bf16 v106, v27, s81, v28
  v_dot2_f32_bf16 v107, v27, s82, v28
  v_mul_f32 v30, v100, v100
  v_fmac_f32 v30, v101, v101
  v_fmac_f32 v30, v102, v102
  v_fmac_f32 v30, v103, v103
  v_fmac_f32 v30, v104, v104
  v_fmac_f32 v30, v105, v105
  v_fmac_f32 v30, v106, v106
  v_fmac_f32 v30, v107, v107
  s_nop 1
  v_add_f32_dpp v30, v30, v30 quad_perm:[1,0,3,2] row_mask:0xf bank_mask:0xf
  s_nop 1
  v_add_f32_dpp v30, v30, v30 quad_perm:[2,3,0,1] row_mask:0xf bank_mask:0xf
  s_nop 1
  v_add_f32_dpp v30, v30, v30 row_half_mirror row_mask:0xf bank_mask:0xf
  s_nop 1
  v_add_f32_dpp v30, v30, v30 row_mirror row_mask:0xf bank_mask:0xf
  v_mov_b32 v29, v30
  s_nop 1
  v_permlane16_swap_b32 v30, v29
  v_add_f32 v30, v30, v29
  v_mov_b32 v29, v30
  s_nop 1
  v_permlane32_swap_b32 v30, v29
  v_add_f32 v30, v30, v29
  v_mul_f32 v30, 0x3b000000, v30
  v_cvt_pk_bf16_f32 v28, v28, v30
  v_and_b32 v30, 0xffff0000, v28
  v_add_f32 v30, 0x3727c5ac, v30
  v_cvt_pk_bf16_f32 v30, v30, v30
  v_and_b32 v30, 0xffff0000, v30
  v_sqrt_f32 v30, v30
  s_nop 0
  v_cvt_pk_bf16_f32 v30, v30, v30
  v_and_b32 v30, 0xffff0000, v30
  v_and_b32 v28, 0xffff, v28
  v_or_b32 v28, v28, v30
  v_lshlrev_b32 v22, 2, v2
  v_add_u32 v22, 161280, v22
  ds_write_b32 v22, v28
  v_lshrrev_b32 v22, 3, v0
  v_mul_u32_u24 v21, 144, v22
  v_and_b32 v31, 7, v0
  v_lshl_add_u32 v21, v31, 4, v21
  v_add_u32 v21, 152064, v21
  v_mul_u32_u24 v22, 8448, v22
  v_lshl_add_u32 v22, v31, 4, v22
  v_mov_b32 v31, 161280
  s_add_u32 s64, s42, 0x00000000
  s_addc_u32 s65, s43, 0
  s_and_b32 s65, s65, 0xffff
  s_mov_b32 s66, 0x00210000
  s_mov_b32 s67, 0x00020000
  s_add_u32 s60, s42, 0x00820000
  s_addc_u32 s61, s43, 0
  s_and_b32 s61, s61, 0xffff
  s_mov_b32 s62, 0x00002000
  s_mov_b32 s63, 0x00020000
  s_waitcnt vmcnt(0)
  s_cmp_ge_u32 s3, 6
  s_cbranch_scc1 JP_WD
  v_perm_b32 v64, v36, v32, s78
  v_perm_b32 v65, v44, v40, s78
  v_perm_b32 v66, v52, v48, s78
  v_perm_b32 v67, v60, v56, s78
  ds_write_b128 v18, v[64:67] offset:0
  v_perm_b32 v68, v36, v32, s79
  v_perm_b32 v69, v44, v40, s79
  v_perm_b32 v70, v52, v48, s79
  v_perm_b32 v71, v60, v56, s79
  ds_write_b128 v18, v[68:71] offset:32
  v_perm_b32 v72, v37, v33, s78
  v_perm_b32 v73, v45, v41, s78
  v_perm_b32 v74, v53, v49, s78
  v_perm_b32 v75, v61, v57, s78
  ds_write_b128 v18, v[72:75] offset:64
  v_perm_b32 v76, v37, v33, s79
  v_perm_b32 v77, v45, v41, s79
  v_perm_b32 v78, v53, v49, s79
  v_perm_b32 v79, v61, v57, s79
  ds_write_b128 v18, v[76:79] offset:96
  v_perm_b32 v80, v38, v34, s78
  v_perm_b32 v81, v46, v42, s78
  v_perm_b32 v82, v54, v50, s78
  v_perm_b32 v83, v62, v58, s78
  ds_write_b128 v18, v[80:83] offset:128
  v_perm_b32 v84, v38, v34, s79
  v_perm_b32 v85, v46, v42, s79
  v_perm_b32 v86, v54, v50, s79
  v_perm_b32 v87, v62, v58, s79
  ds_write_b128 v18, v[84:87] offset:160
  v_perm_b32 v88, v39, v35, s78
  v_perm_b32 v89, v47, v43, s78
  v_perm_b32 v90, v55, v51, s78
  v_perm_b32 v91, v63, v59, s78
  ds_write_b128 v18, v[88:91] offset:192
  v_perm_b32 v92, v39, v35, s79
  v_perm_b32 v93, v47, v43, s79
  v_perm_b32 v94, v55, v51, s79
  v_perm_b32 v95, v63, v59, s79
  ds_write_b128 v18, v[92:95] offset:224
  s_cmp_ge_u32 s3, 3
  s_cbranch_scc1 JP_DONE
  ds_write_b32 v18, v19 offset:256
  s_branch JP_DONE
JP_WD:
  v_perm_b32 v64, v36, v32, s78
  v_perm_b32 v65, v44, v40, s78
  v_perm_b32 v66, v52, v48, s78
  v_perm_b32 v67, v60, v56, s78
  ds_write_b128 v18, v[64:67] offset:0
  v_perm_b32 v68, v36, v32, s79
  v_perm_b32 v69, v44, v40, s79
  v_perm_b32 v70, v52, v48, s79
  v_perm_b32 v71, v60, v56, s79
  ds_write_b128 v18, v[68:71] offset:16
  v_perm_b32 v72, v37, v33, s78
  v_perm_b32 v73, v45, v41, s78
  v_perm_b32 v74, v53, v49, s78
  v_perm_b32 v75, v61, v57, s78
  ds_write_b128 v18, v[72:75] offset:32
  v_perm_b32 v76, v37, v33, s79
  v_perm_b32 v77, v45, v41, s79
  v_perm_b32 v78, v53, v49, s79
  v_perm_b32 v79, v61, v57, s79
  ds_write_b128 v18, v[76:79] offset:48
  v_perm_b32 v80, v38, v34, s78
  v_perm_b32 v81, v46, v42, s78
  v_perm_b32 v82, v54, v50, s78
  v_perm_b32 v83, v62, v58, s78
  ds_write_b128 v18, v[80:83] offset:64
  v_perm_b32 v84, v38, v34, s79
  v_perm_b32 v85, v46, v42, s79
  v_perm_b32 v86, v54, v50, s79
  v_perm_b32 v87, v62, v58, s79
  ds_write_b128 v18, v[84:87] offset:80
  v_perm_b32 v88, v39, v35, s78
  v_perm_b32 v89, v47, v43, s78
  v_perm_b32 v90, v55, v51, s78
  v_perm_b32 v91, v63, v59, s78
  ds_write_b128 v18, v[88:91] offset:96
  v_perm_b32 v92, v39, v35, s79
  v_perm_b32 v93, v47, v43, s79
  v_perm_b32 v94, v55, v51, s79
  v_perm_b32 v95, v63, v59, s79
  ds_write_b128 v18, v[92:95] offset:112
  ds_write_b32 v18, v19 offset:128
JP_DONE:
  v_lshrrev_b32 v17, 4, v0
  v_mul_u32_u24 v17, 272, v17
  v_add_u32 v17, 117248, v17
  v_and_b32 v18, 15, v0
  v_lshlrev_b32 v18, 4, v18
  v_add_u32 v19, v17, v18
  v_lshrrev_b32 v23, 3, v0
  v_min_u32 v23, 42, v23
  v_mul_u32_u24 v23, 144, v23
  v_add_u32 v23, 128944, v23
  v_and_b32 v29, 7, v0
  v_lshlrev_b32 v29, 4, v29
  v_add_u32 v30, v23, v29
  s_add_u32 s52, s42, 0x00900000
  s_addc_u32 s53, s43, 0
  s_and_b32 s53, s53, 0xffff
  s_mov_b32 s54, 0x002bac00
  s_mov_b32 s55, 0x00020000
  s_add_u32 s56, s42, 0x00c00000
  s_addc_u32 s57, s43, 0
  s_and_b32 s57, s57, 0xffff
  s_mov_b32 s58, 0x00158000
  s_mov_b32 s59, 0x00020000
  s_cmp_lg_u32 s3, 5
  s_cbranch_scc1 NONL
  v_mov_b32 v8, 0
  buffer_load_dword v9, v8, s[72:75], 0 offen sc0 sc1
NONL:
  s_waitcnt lgkmcnt(0)
  s_barrier
  ds_read_b128 v[100:103], v19
  ds_read_b32 v108, v17 offset:256
  ds_read_b128 v[104:107], v19 offset:8704
  ds_read_b32 v109, v17 offset:8960
  ds_read_b128 v[24:27], v21
  ds_read_b128 v[112:115], v31
  ds_read_b128 v[116:119], v31 offset:16
  s_and_b32 s76, s2, 3
  s_mul_i32 s76, s76, 540672
  s_lshr_b32 s77, s2, 2
  s_lshl_b32 s77, s77, 7
  s_add_u32 s76, s76, s77
  s_lshl_b32 s77, s2, 5
  v_mov_b32 v31, 0
  s_waitcnt lgkmcnt(2)
  buffer_store_dwordx4 v[24:27], v22, s[64:67], s76 offen sc1
  s_cmp_lg_u32 s3, 0
  s_cbranch_scc1 NOSTAT
  s_waitcnt lgkmcnt(0)
  s_mov_b64 exec, 1
  buffer_store_dwordx4 v[112:115], v31, s[60:63], s77 offen sc1
  buffer_store_dwordx4 v[116:119], v31, s[60:63], s77 offen offset:16 sc1
  s_mov_b64 exec, -1
NOSTAT:
  v_add_u32 v108, v108, v18
  v_add_u32 v109, v109, v18
  v_mov_b32 v47, 0x7f000000
  v_cmp_gt_u32 vcc, 176, v0
  s_nop 1
  v_cndmask_b32 v109, v47, v109, vcc
P2:
  s_bfe_u32 s6, s3, 0x10001
  s_mov_b32 s64, 0x44000000
  s_mov_b32 s65, 0x43000000
  s_mov_b32 s66, 0x40800000
  s_mov_b32 s67, 0x42800000
  s_cmp_eq_u32 s6, 0
  s_cmov_b32 s64, 0
  s_cmov_b32 s65, 0x42000000
  s_cmov_b32 s66, 0x3f800000
  s_cmov_b32 s67, 0x41800000
  s_mov_b32 s8, 0x3fb8aa00
  s_mov_b32 s9, 0x36a407db
  s_mul_i32 s10, s4, 52224
  s_mul_i32 s11, s6, 8704
  s_add_u32 s11, s11, s10
  s_mul_i32 s12, s6, 17408
  s_add_u32 s12, s12, s10
  v_lshlrev_b32 v20, 2, v3
  v_add_u32 v21, s11, v20
  v_add_u32 v22, s12, v20
  v_lshlrev_b32 v10, 16, v10
  v_lshlrev_b32 v11, 16, v11
  v_lshlrev_b32 v12, 16, v12
  v_lshlrev_b32 v13, 16, v13
  v_lshlrev_b32 v16, 16, v16
  v_and_b32 v14, 0x7fff7fff, v14
  v_and_b32 v15, 0x7fff7fff, v15
  v_pk_max_u16 v14, v14, v15
  v_lshrrev_b32 v15, 16, v14
  v_and_b32 v14, 0xffff, v14
  v_max_u32 v14, v14, v15
  v_mul_f32 v24, s8, v16
  v_mul_f32 v25, s9, v16
  v_exp_f32 v24, v24
  s_nop 0
  v_fma_f32 v24, v24, v25, v24
  v_cvt_pk_bf16_f32 v24, v24, v24
  v_and_b32 v16, 0xffff0000, v24
  v_mul_f32 v26, s8, v10
  v_mul_f32 v27, s9, v10
  v_exp_f32 v26, v26
  s_nop 0
  v_fma_f32 v26, v26, v27, v26
  v_cvt_pk_bf16_f32 v26, v26, v26
  v_and_b32 v10, 0xffff0000, v26
  v_max_u32_dpp v14, v14, v14 quad_perm:[1,0,3,2] row_mask:0xf bank_mask:0xf
  s_nop 1
  v_max_u32_dpp v14, v14, v14 quad_perm:[2,3,0,1] row_mask:0xf bank_mask:0xf
  s_nop 1
  v_max_u32_dpp v14, v14, v14 row_half_mirror row_mask:0xf bank_mask:0xf
  s_nop 1
  v_max_u32_dpp v14, v14, v14 row_mirror row_mask:0xf bank_mask:0xf
  v_mov_b32 v15, v14
  s_nop 1
  v_permlane16_swap_b32 v14, v15
  v_max_u32 v14, v14, v15
  v_mov_b32 v15, v14
  s_nop 1
  v_permlane32_swap_b32 v14, v15
  v_max_u32 v14, v14, v15
  v_lshrrev_b32 v14, 7, v14
  v_max_u32 v14, 1, v14
  v_min_u32 v14, 0xfd, v14
  v_lshrrev_b32 v15, 23, v16
  v_max_u32 v15, 1, v15
  v_min_u32 v15, 0xfd, v15
  v_sub_u32 v24, 254, v14
  v_lshlrev_b32 v24, 23, v24
  v_sub_u32 v25, 254, v15
  v_lshlrev_b32 v25, 23, v25
  v_lshlrev_b32 v14, 23, v14
  v_lshlrev_b32 v15, 23, v15
  v_mul_f32 v14, v14, v15
  v_add_f32 v14, v14, v14
  v_mul_f32 v12, v12, v24
  v_mul_f32 v13, v13, v24
  v_mul_f32 v25, v16, v25
  v_mul_f32 v12, v12, v25
  v_mul_f32 v13, v13, v25
  v_mul_f32 v10, v10, v16
  v_mul_f32 v10, 0xbfb8aa3b, v10
  v_mul_f32 v11, v11, v16
  v_mul_f32 v11, 0x3e22f983, v11
  s_lshl_b32 s13, s4, 2
  s_add_u32 s13, s13, 116992
  v_mov_b32 v7, s13
  ds_write_b32 v7, v14
  s_and_b32 s16, s2, 7
  s_lshr_b32 s17, s2, 3
  s_lshr_b32 s18, s16, 1
  s_lshl_b32 s18, s18, 2
  s_and_b32 s19, s17, 3
  s_add_u32 s18, s18, s19
  s_and_b32 s19, s16, 1
  s_lshl_b32 s19, s19, 3
  s_lshr_b32 s20, s17, 2
  s_add_u32 s19, s19, s20
  s_lshl_b32 s24, s18, 4
  s_add_u32 s24, s24, s19
  s_lshl_b32 s24, s24, 7
  s_getreg_b32 s27, hwreg(HW_REG_XCC_ID, 0, 3)
  s_lshl_b32 s27, s27, 3
  s_add_u32 s76, s42, 0x00830000
  s_addc_u32 s77, s43, 0
  s_and_b32 s77, s77, 0xffff
  s_mov_b32 s78, 0x00008000
  s_mov_b32 s79, 0x00020000
  s_waitcnt vmcnt(0)
  s_barrier
  s_cmp_lg_u32 s3, 5
  s_cbranch_scc1 SIG_A
  v_mov_b32 v6, 0
  s_mov_b64 exec, 1
  v_mov_b32 v5, v9
  v_cmp_ne_u32 vcc, 0, v5
  s_nop 0
  s_and_b64 vcc, vcc, exec
  s_cbranch_vccnz WD_N
  s_mov_b32 s15, 0x40000
WL_N:
  buffer_load_dword v5, v6, s[72:75], 0 offen sc0 sc1
  s_waitcnt vmcnt(0)
  v_cmp_eq_u32 vcc, 0, v5
  s_sub_u32 s15, s15, 1
  s_cmp_eq_u32 s15, 0
  s_cbranch_scc1 WD_N
  s_and_b64 vcc, vcc, exec
  s_cbranch_vccz WD_N
  s_sleep 4
  s_branch WL_N
WD_N:
  s_mov_b64 exec, -1
  v_readfirstlane_b32 s25, v5
  s_nop 3
  s_add_u32 s14, s25, 1
  s_add_u32 s14, s14, s27
  v_mov_b32 v5, s14
  s_mov_b64 exec, 1
  buffer_store_dword v5, v6, s[76:79], s24 offen sc0 sc1
  s_mov_b64 exec, -1
SIG_A:
  buffer_store_dwordx4 v[100:103], v108, s[52:55], 0 offen sc1
  buffer_store_dwordx4 v[104:107], v109, s[52:55], 0 offen sc1
  v_mul_f32 v40, s64, v10
  v_mul_f32 v41, s64, v11
  v_exp_f32 v40, v40
  v_fract_f32 v41, v41
  v_cos_f32 v30, v41
  v_sin_f32 v31, v41
  v_mul_f32 v30, v30, v40
  v_mul_f32 v31, v31, v40
  v_mul_f32 v42, s65, v10
  v_mul_f32 v43, s65, v11
  v_exp_f32 v42, v42
  v_fract_f32 v43, v43
  v_cos_f32 v36, v43
  v_sin_f32 v37, v43
  v_mul_f32 v36, v36, v42
  v_mul_f32 v37, v37, v42
  v_mul_f32 v44, s66, v10
  v_mul_f32 v45, s66, v11
  v_exp_f32 v44, v44
  v_fract_f32 v45, v45
  v_cos_f32 v38, v45
  v_sin_f32 v39, v45
  v_mul_f32 v38, v38, v44
  v_mul_f32_e64 v39, v39, -v44
  v_mul_f32 v46, s67, v10
  v_mul_f32 v47, s67, v11
  v_exp_f32 v46, v46
  v_fract_f32 v47, v47
  v_cos_f32 v34, v47
  v_sin_f32 v35, v47
  v_mul_f32 v34, v34, v46
  v_mul_f32_e64 v35, v35, -v46
  v_pk_mul_f32 v[40:41], v[30:31], v[12:13] op_sel:[0,0] op_sel_hi:[0,1]
  v_pk_fma_f32 v[30:31], v[30:31], v[12:13], v[40:41] op_sel:[1,1,0] op_sel_hi:[1,0,1] neg_lo:[0,1,0]
  v_mov_b32 v32, 1.0
  v_mov_b32 v33, 0
  v_cvt_pk_f16_f32 v50, v30, v31
  v_cvt_pk_f16_f32 v51, v32, v33
  v_cvt_pk_f16_f32 v52, v34, v35
  ds_write_b32 v21, v50 offset:0
  ds_write_b32 v22, v51 offset:17408
  ds_write_b32 v22, v52 offset:26112
  v_pk_mul_f32 v[40:41], v[30:31], v[36:37] op_sel:[0,0] op_sel_hi:[0,1]
  v_pk_fma_f32 v[30:31], v[30:31], v[36:37], v[40:41] op_sel:[1,1,0] op_sel_hi:[1,0,1] neg_lo:[0,1,0]
  v_pk_mul_f32 v[42:43], v[32:33], v[38:39] op_sel:[0,0] op_sel_hi:[0,1]
  v_pk_fma_f32 v[32:33], v[32:33], v[38:39], v[42:43] op_sel:[1,1,0] op_sel_hi:[1,0,1] neg_lo:[0,1,0]
  v_pk_mul_f32 v[44:45], v[34:35], v[38:39] op_sel:[0,0] op_sel_hi:[0,1]
  v_pk_fma_f32 v[34:35], v[34:35], v[38:39], v[44:45] op_sel:[1,1,0] op_sel_hi:[1,0,1] neg_lo:[0,1,0]
  v_cvt_pk_f16_f32 v53, v30, v31
  v_cvt_pk_f16_f32 v54, v32, v33
  v_cvt_pk_f16_f32 v55, v34, v35
  ds_write_b32 v21, v53 offset:544
  ds_write_b32 v22, v54 offset:17952
  ds_write_b32 v22, v55 offset:26656
  v_pk_mul_f32 v[40:41], v[30:31], v[36:37] op_sel:[0,0] op_sel_hi:[0,1]
  v_pk_fma_f32 v[30:31], v[30:31], v[36:37], v[40:41] op_sel:[1,1,0] op_sel_hi:[1,0,1] neg_lo:[0,1,0]
  v_pk_mul_f32 v[42:43], v[32:33], v[38:39] op_sel:[0,0] op_sel_hi:[0,1]
  v_pk_fma_f32 v[32:33], v[32:33], v[38:39], v[42:43] op_sel:[1,1,0] op_sel_hi:[1,0,1] neg_lo:[0,1,0]
  v_pk_mul_f32 v[44:45], v[34:35], v[38:39] op_sel:[0,0] op_sel_hi:[0,1]
  v_pk_fma_f32 v[34:35], v[34:35], v[38:39], v[44:45] op_sel:[1,1,0] op_sel_hi:[1,0,1] neg_lo:[0,1,0]
  v_cvt_pk_f16_f32 v50, v30, v31
  v_cvt_pk_f16_f32 v51, v32, v33
  v_cvt_pk_f16_f32 v52, v34, v35
  ds_write_b32 v21, v50 offset:1088
  ds_write_b32 v22, v51 offset:18496
  ds_write_b32 v22, v52 offset:27200
  v_pk_mul_f32 v[40:41], v[30:31], v[36:37] op_sel:[0,0] op_sel_hi:[0,1]
  v_pk_fma_f32 v[30:31], v[30:31], v[36:37], v[40:41] op_sel:[1,1,0] op_sel_hi:[1,0,1] neg_lo:[0,1,0]
  v_pk_mul_f32 v[42:43], v[32:33], v[38:39] op_sel:[0,0] op_sel_hi:[0,1]
  v_pk_fma_f32 v[32:33], v[32:33], v[38:39], v[42:43] op_sel:[1,1,0] op_sel_hi:[1,0,1] neg_lo:[0,1,0]
  v_pk_mul_f32 v[44:45], v[34:35], v[38:39] op_sel:[0,0] op_sel_hi:[0,1]
  v_pk_fma_f32 v[34:35], v[34:35], v[38:39], v[44:45] op_sel:[1,1,0] op_sel_hi:[1,0,1] neg_lo:[0,1,0]
  v_cvt_pk_f16_f32 v53, v30, v31
  v_cvt_pk_f16_f32 v54, v32, v33
  v_cvt_pk_f16_f32 v55, v34, v35
  ds_write_b32 v21, v53 offset:1632
  ds_write_b32 v22, v54 offset:19040
  ds_write_b32 v22, v55 offset:27744
  v_pk_mul_f32 v[40:41], v[30:31], v[36:37] op_sel:[0,0] op_sel_hi:[0,1]
  v_pk_fma_f32 v[30:31], v[30:31], v[36:37], v[40:41] op_sel:[1,1,0] op_sel_hi:[1,0,1] neg_lo:[0,1,0]
  v_pk_mul_f32 v[42:43], v[32:33], v[38:39] op_sel:[0,0] op_sel_hi:[0,1]
  v_pk_fma_f32 v[32:33], v[32:33], v[38:39], v[42:43] op_sel:[1,1,0] op_sel_hi:[1,0,1] neg_lo:[0,1,0]
  v_pk_mul_f32 v[44:45], v[34:35], v[38:39] op_sel:[0,0] op_sel_hi:[0,1]
  v_pk_fma_f32 v[34:35], v[34:35], v[38:39], v[44:45] op_sel:[1,1,0] op_sel_hi:[1,0,1] neg_lo:[0,1,0]
  v_cvt_pk_f16_f32 v50, v30, v31
  v_cvt_pk_f16_f32 v51, v32, v33
  v_cvt_pk_f16_f32 v52, v34, v35
  ds_write_b32 v21, v50 offset:2176
  ds_write_b32 v22, v51 offset:19584
  ds_write_b32 v22, v52 offset:28288
  v_pk_mul_f32 v[40:41], v[30:31], v[36:37] op_sel:[0,0] op_sel_hi:[0,1]
  v_pk_fma_f32 v[30:31], v[30:31], v[36:37], v[40:41] op_sel:[1,1,0] op_sel_hi:[1,0,1] neg_lo:[0,1,0]
  v_pk_mul_f32 v[42:43], v[32:33], v[38:39] op_sel:[0,0] op_sel_hi:[0,1]
  v_pk_fma_f32 v[32:33], v[32:33], v[38:39], v[42:43] op_sel:[1,1,0] op_sel_hi:[1,0,1] neg_lo:[0,1,0]
  v_pk_mul_f32 v[44:45], v[34:35], v[38:39] op_sel:[0,0] op_sel_hi:[0,1]
  v_pk_fma_f32 v[34:35], v[34:35], v[38:39], v[44:45] op_sel:[1,1,0] op_sel_hi:[1,0,1] neg_lo:[0,1,0]
  v_cvt_pk_f16_f32 v53, v30, v31
  v_cvt_pk_f16_f32 v54, v32, v33
  v_cvt_pk_f16_f32 v55, v34, v35
  ds_write_b32 v21, v53 offset:2720
  ds_write_b32 v22, v54 offset:20128
  ds_write_b32 v22, v55 offset:28832
  v_pk_mul_f32 v[40:41], v[30:31], v[36:37] op_sel:[0,0] op_sel_hi:[0,1]
  v_pk_fma_f32 v[30:31], v[30:31], v[36:37], v[40:41] op_sel:[1,1,0] op_sel_hi:[1,0,1] neg_lo:[0,1,0]
  v_pk_mul_f32 v[42:43], v[32:33], v[38:39] op_sel:[0,0] op_sel_hi:[0,1]
  v_pk_fma_f32 v[32:33], v[32:33], v[38:39], v[42:43] op_sel:[1,1,0] op_sel_hi:[1,0,1] neg_lo:[0,1,0]
  v_pk_mul_f32 v[44:45], v[34:35], v[38:39] op_sel:[0,0] op_sel_hi:[0,1]
  v_pk_fma_f32 v[34:35], v[34:35], v[38:39], v[44:45] op_sel:[1,1,0] op_sel_hi:[1,0,1] neg_lo:[0,1,0]
  v_cvt_pk_f16_f32 v50, v30, v31
  v_cvt_pk_f16_f32 v51, v32, v33
  v_cvt_pk_f16_f32 v52, v34, v35
  ds_write_b32 v21, v50 offset:3264
  ds_write_b32 v22, v51 offset:20672
  ds_write_b32 v22, v52 offset:29376
  v_pk_mul_f32 v[40:41], v[30:31], v[36:37] op_sel:[0,0] op_sel_hi:[0,1]
  v_pk_fma_f32 v[30:31], v[30:31], v[36:37], v[40:41] op_sel:[1,1,0] op_sel_hi:[1,0,1] neg_lo:[0,1,0]
  v_pk_mul_f32 v[42:43], v[32:33], v[38:39] op_sel:[0,0] op_sel_hi:[0,1]
  v_pk_fma_f32 v[32:33], v[32:33], v[38:39], v[42:43] op_sel:[1,1,0] op_sel_hi:[1,0,1] neg_lo:[0,1,0]
  v_pk_mul_f32 v[44:45], v[34:35], v[38:39] op_sel:[0,0] op_sel_hi:[0,1]
  v_pk_fma_f32 v[34:35], v[34:35], v[38:39], v[44:45] op_sel:[1,1,0] op_sel_hi:[1,0,1] neg_lo:[0,1,0]
  v_cvt_pk_f16_f32 v53, v30, v31
  v_cvt_pk_f16_f32 v54, v32, v33
  v_cvt_pk_f16_f32 v55, v34, v35
  ds_write_b32 v21, v53 offset:3808
  ds_write_b32 v22, v54 offset:21216
  ds_write_b32 v22, v55 offset:29920
  v_pk_mul_f32 v[40:41], v[30:31], v[36:37] op_sel:[0,0] op_sel_hi:[0,1]
  v_pk_fma_f32 v[30:31], v[30:31], v[36:37], v[40:41] op_sel:[1,1,0] op_sel_hi:[1,0,1] neg_lo:[0,1,0]
  v_pk_mul_f32 v[42:43], v[32:33], v[38:39] op_sel:[0,0] op_sel_hi:[0,1]
  v_pk_fma_f32 v[32:33], v[32:33], v[38:39], v[42:43] op_sel:[1,1,0] op_sel_hi:[1,0,1] neg_lo:[0,1,0]
  v_pk_mul_f32 v[44:45], v[34:35], v[38:39] op_sel:[0,0] op_sel_hi:[0,1]
  v_pk_fma_f32 v[34:35], v[34:35], v[38:39], v[44:45] op_sel:[1,1,0] op_sel_hi:[1,0,1] neg_lo:[0,1,0]
  v_cvt_pk_f16_f32 v50, v30, v31
  v_cvt_pk_f16_f32 v51, v32, v33
  v_cvt_pk_f16_f32 v52, v34, v35
  ds_write_b32 v21, v50 offset:4352
  ds_write_b32 v22, v51 offset:21760
  ds_write_b32 v22, v52 offset:30464
  v_pk_mul_f32 v[40:41], v[30:31], v[36:37] op_sel:[0,0] op_sel_hi:[0,1]
  v_pk_fma_f32 v[30:31], v[30:31], v[36:37], v[40:41] op_sel:[1,1,0] op_sel_hi:[1,0,1] neg_lo:[0,1,0]
  v_pk_mul_f32 v[42:43], v[32:33], v[38:39] op_sel:[0,0] op_sel_hi:[0,1]
  v_pk_fma_f32 v[32:33], v[32:33], v[38:39], v[42:43] op_sel:[1,1,0] op_sel_hi:[1,0,1] neg_lo:[0,1,0]
  v_pk_mul_f32 v[44:45], v[34:35], v[38:39] op_sel:[0,0] op_sel_hi:[0,1]
  v_pk_fma_f32 v[34:35], v[34:35], v[38:39], v[44:45] op_sel:[1,1,0] op_sel_hi:[1,0,1] neg_lo:[0,1,0]
  v_cvt_pk_f16_f32 v53, v30, v31
  v_cvt_pk_f16_f32 v54, v32, v33
  v_cvt_pk_f16_f32 v55, v34, v35
  ds_write_b32 v21, v53 offset:4896
  ds_write_b32 v22, v54 offset:22304
  ds_write_b32 v22, v55 offset:31008
  v_pk_mul_f32 v[40:41], v[30:31], v[36:37] op_sel:[0,0] op_sel_hi:[0,1]
  v_pk_fma_f32 v[30:31], v[30:31], v[36:37], v[40:41] op_sel:[1,1,0] op_sel_hi:[1,0,1] neg_lo:[0,1,0]
  v_pk_mul_f32 v[42:43], v[32:33], v[38:39] op_sel:[0,0] op_sel_hi:[0,1]
  v_pk_fma_f32 v[32:33], v[32:33], v[38:39], v[42:43] op_sel:[1,1,0] op_sel_hi:[1,0,1] neg_lo:[0,1,0]
  v_pk_mul_f32 v[44:45], v[34:35], v[38:39] op_sel:[0,0] op_sel_hi:[0,1]
  v_pk_fma_f32 v[34:35], v[34:35], v[38:39], v[44:45] op_sel:[1,1,0] op_sel_hi:[1,0,1] neg_lo:[0,1,0]
  v_cvt_pk_f16_f32 v50, v30, v31
  v_cvt_pk_f16_f32 v51, v32, v33
  v_cvt_pk_f16_f32 v52, v34, v35
  ds_write_b32 v21, v50 offset:5440
  ds_write_b32 v22, v51 offset:22848
  ds_write_b32 v22, v52 offset:31552
  v_pk_mul_f32 v[40:41], v[30:31], v[36:37] op_sel:[0,0] op_sel_hi:[0,1]
  v_pk_fma_f32 v[30:31], v[30:31], v[36:37], v[40:41] op_sel:[1,1,0] op_sel_hi:[1,0,1] neg_lo:[0,1,0]
  v_pk_mul_f32 v[42:43], v[32:33], v[38:39] op_sel:[0,0] op_sel_hi:[0,1]
  v_pk_fma_f32 v[32:33], v[32:33], v[38:39], v[42:43] op_sel:[1,1,0] op_sel_hi:[1,0,1] neg_lo:[0,1,0]
  v_pk_mul_f32 v[44:45], v[34:35], v[38:39] op_sel:[0,0] op_sel_hi:[0,1]
  v_pk_fma_f32 v[34:35], v[34:35], v[38:39], v[44:45] op_sel:[1,1,0] op_sel_hi:[1,0,1] neg_lo:[0,1,0]
  v_cvt_pk_f16_f32 v53, v30, v31
  v_cvt_pk_f16_f32 v54, v32, v33
  v_cvt_pk_f16_f32 v55, v34, v35
  ds_write_b32 v21, v53 offset:5984
  ds_write_b32 v22, v54 offset:23392
  ds_write_b32 v22, v55 offset:32096
  v_pk_mul_f32 v[40:41], v[30:31], v[36:37] op_sel:[0,0] op_sel_hi:[0,1]
  v_pk_fma_f32 v[30:31], v[30:31], v[36:37], v[40:41] op_sel:[1,1,0] op_sel_hi:[1,0,1] neg_lo:[0,1,0]
  v_pk_mul_f32 v[42:43], v[32:33], v[38:39] op_sel:[0,0] op_sel_hi:[0,1]
  v_pk_fma_f32 v[32:33], v[32:33], v[38:39], v[42:43] op_sel:[1,1,0] op_sel_hi:[1,0,1] neg_lo:[0,1,0]
  v_pk_mul_f32 v[44:45], v[34:35], v[38:39] op_sel:[0,0] op_sel_hi:[0,1]
  v_pk_fma_f32 v[34:35], v[34:35], v[38:39], v[44:45] op_sel:[1,1,0] op_sel_hi:[1,0,1] neg_lo:[0,1,0]
  v_cvt_pk_f16_f32 v50, v30, v31
  v_cvt_pk_f16_f32 v51, v32, v33
  v_cvt_pk_f16_f32 v52, v34, v35
  ds_write_b32 v21, v50 offset:6528
  ds_write_b32 v22, v51 offset:23936
  ds_write_b32 v22, v52 offset:32640
  v_pk_mul_f32 v[40:41], v[30:31], v[36:37] op_sel:[0,0] op_sel_hi:[0,1]
  v_pk_fma_f32 v[30:31], v[30:31], v[36:37], v[40:41] op_sel:[1,1,0] op_sel_hi:[1,0,1] neg_lo:[0,1,0]
  v_pk_mul_f32 v[42:43], v[32:33], v[38:39] op_sel:[0,0] op_sel_hi:[0,1]
  v_pk_fma_f32 v[32:33], v[32:33], v[38:39], v[42:43] op_sel:[1,1,0] op_sel_hi:[1,0,1] neg_lo:[0,1,0]
  v_pk_mul_f32 v[44:45], v[34:35], v[38:39] op_sel:[0,0] op_sel_hi:[0,1]
  v_pk_fma_f32 v[34:35], v[34:35], v[38:39], v[44:45] op_sel:[1,1,0] op_sel_hi:[1,0,1] neg_lo:[0,1,0]
  v_cvt_pk_f16_f32 v53, v30, v31
  v_cvt_pk_f16_f32 v54, v32, v33
  v_cvt_pk_f16_f32 v55, v34, v35
  ds_write_b32 v21, v53 offset:7072
  ds_write_b32 v22, v54 offset:24480
  ds_write_b32 v22, v55 offset:33184
  v_pk_mul_f32 v[40:41], v[30:31], v[36:37] op_sel:[0,0] op_sel_hi:[0,1]
  v_pk_fma_f32 v[30:31], v[30:31], v[36:37], v[40:41] op_sel:[1,1,0] op_sel_hi:[1,0,1] neg_lo:[0,1,0]
  v_pk_mul_f32 v[42:43], v[32:33], v[38:39] op_sel:[0,0] op_sel_hi:[0,1]
  v_pk_fma_f32 v[32:33], v[32:33], v[38:39], v[42:43] op_sel:[1,1,0] op_sel_hi:[1,0,1] neg_lo:[0,1,0]
  v_pk_mul_f32 v[44:45], v[34:35], v[38:39] op_sel:[0,0] op_sel_hi:[0,1]
  v_pk_fma_f32 v[34:35], v[34:35], v[38:39], v[44:45] op_sel:[1,1,0] op_sel_hi:[1,0,1] neg_lo:[0,1,0]
  v_cvt_pk_f16_f32 v50, v30, v31
  v_cvt_pk_f16_f32 v51, v32, v33
  v_cvt_pk_f16_f32 v52, v34, v35
  ds_write_b32 v21, v50 offset:7616
  ds_write_b32 v22, v51 offset:25024
  ds_write_b32 v22, v52 offset:33728
  v_pk_mul_f32 v[40:41], v[30:31], v[36:37] op_sel:[0,0] op_sel_hi:[0,1]
  v_pk_fma_f32 v[30:31], v[30:31], v[36:37], v[40:41] op_sel:[1,1,0] op_sel_hi:[1,0,1] neg_lo:[0,1,0]
  v_pk_mul_f32 v[42:43], v[32:33], v[38:39] op_sel:[0,0] op_sel_hi:[0,1]
  v_pk_fma_f32 v[32:33], v[32:33], v[38:39], v[42:43] op_sel:[1,1,0] op_sel_hi:[1,0,1] neg_lo:[0,1,0]
  v_pk_mul_f32 v[44:45], v[34:35], v[38:39] op_sel:[0,0] op_sel_hi:[0,1]
  v_pk_fma_f32 v[34:35], v[34:35], v[38:39], v[44:45] op_sel:[1,1,0] op_sel_hi:[1,0,1] neg_lo:[0,1,0]
  v_cvt_pk_f16_f32 v53, v30, v31
  v_cvt_pk_f16_f32 v54, v32, v33
  v_cvt_pk_f16_f32 v55, v34, v35
  ds_write_b32 v21, v53 offset:8160
  ds_write_b32 v22, v54 offset:25568
  ds_write_b32 v22, v55 offset:34272
  s_and_b32 s7, s3, 1
  v_and_b32 v3, 15, v1
  v_lshrrev_b32 v4, 4, v1
  v_mul_u32_u24 v7, 544, v3
  v_lshl_add_u32 v7, v4, 4, v7
  s_mul_i32 s13, s7, 8704
  s_add_u32 s13, s13, s12
  v_add_u32 v8, s13, v7
  v_add_u32 v9, s11, v7
  s_lshl_b32 s13, s6, 10
  s_lshl_b32 s14, s7, 5
  s_add_u32 s13, s13, s14
  s_lshl_b32 s14, s4, 11
  s_add_u32 s13, s13, s14
  s_add_u32 s13, s13, 104448
  v_lshlrev_b32 v20, 6, v3
  v_lshl_add_u32 v20, v4, 3, v20
  v_add_u32 v20, s13, v20
  s_waitcnt lgkmcnt(0)
  s_barrier
  s_and_b32 s13, s2, 15
  s_lshl_b32 s13, s13, 2
  ds_read_b128 v[64:67], v8 offset:17408
  ds_read_b128 v[96:99], v9 offset:0
  ds_read_b128 v[68:71], v8 offset:17472
  ds_read_b128 v[100:103], v9 offset:64
  ds_read_b128 v[72:75], v8 offset:17536
  ds_read_b128 v[104:107], v9 offset:128
  ds_read_b128 v[76:79], v8 offset:17600
  ds_read_b128 v[108:111], v9 offset:192
  ds_read_b128 v[80:83], v8 offset:17664
  ds_read_b128 v[112:115], v9 offset:256
  ds_read_b128 v[84:87], v8 offset:17728
  ds_read_b128 v[116:119], v9 offset:320
  ds_read_b128 v[88:91], v8 offset:17792
  ds_read_b128 v[120:123], v9 offset:384
  ds_read_b128 v[92:95], v8 offset:17856
  ds_read_b128 v[124:127], v9 offset:448
  s_waitcnt lgkmcnt(14)
  v_mfma_f32_16x16x32_f16 v[60:63], v[64:67], v[96:99], 0
  s_waitcnt lgkmcnt(12)
  v_mfma_f32_16x16x32_f16 v[60:63], v[68:71], v[100:103], v[60:63]
  s_waitcnt lgkmcnt(10)
  v_mfma_f32_16x16x32_f16 v[60:63], v[72:75], v[104:107], v[60:63]
  s_waitcnt lgkmcnt(8)
  v_mfma_f32_16x16x32_f16 v[60:63], v[76:79], v[108:111], v[60:63]
  s_waitcnt lgkmcnt(6)
  v_mfma_f32_16x16x32_f16 v[60:63], v[80:83], v[112:115], v[60:63]
  s_waitcnt lgkmcnt(4)
  v_mfma_f32_16x16x32_f16 v[60:63], v[84:87], v[116:119], v[60:63]
  s_waitcnt lgkmcnt(2)
  v_mfma_f32_16x16x32_f16 v[60:63], v[88:91], v[120:123], v[60:63]
  s_waitcnt lgkmcnt(0)
  v_mfma_f32_16x16x32_f16 v[60:63], v[92:95], v[124:127], v[60:63]
  v_and_b32 v23, 255, v0
  v_lshlrev_b32 v21, 3, v23
  v_sub_u32 v21, 2047, v21
  v_subrev_u32 v30, 0, v21
  v_subrev_u32 v31, 1, v21
  v_subrev_u32 v32, 2, v21
  v_subrev_u32 v33, 3, v21
  v_subrev_u32 v34, 4, v21
  v_subrev_u32 v35, 5, v21
  v_subrev_u32 v36, 6, v21
  v_subrev_u32 v37, 7, v21
  v_cvt_f32_u32 v30, v30
  v_cvt_f32_u32 v31, v31
  v_cvt_f32_u32 v32, v32
  v_cvt_f32_u32 v33, v33
  v_cvt_f32_u32 v34, v34
  v_cvt_f32_u32 v35, v35
  v_cvt_f32_u32 v36, v36
  v_cvt_f32_u32 v37, v37
  v_cvt_pk_bf16_f32 v40, v30, v31
  v_cvt_pk_bf16_f32 v41, v32, v33
  v_cvt_pk_bf16_f32 v42, v34, v35
  v_cvt_pk_bf16_f32 v43, v36, v37
  v_lshlrev_b32 v30, 16, v40
  v_and_b32 v31, 0xffff0000, v40
  v_lshlrev_b32 v32, 16, v41
  v_and_b32 v33, 0xffff0000, v41
  v_lshlrev_b32 v34, 16, v42
  v_and_b32 v35, 0xffff0000, v42
  v_lshlrev_b32 v36, 16, v43
  v_and_b32 v37, 0xffff0000, v43
  v_cvt_u32_f32 v30, v30
  v_cvt_u32_f32 v31, v31
  v_cvt_u32_f32 v32, v32
  v_cvt_u32_f32 v33, v33
  v_cvt_u32_f32 v34, v34
  v_cvt_u32_f32 v35, v35
  v_cvt_u32_f32 v36, v36
  v_cvt_u32_f32 v37, v37
  s_lshl_b32 s14, s4, 11
  s_add_u32 s14, s14, 104448
  v_lshrrev_b32 v40, 2, v30
  v_add_u32 v40, 384, v40
  v_min_u32 v30, v30, v40
  v_lshl_add_u32 v30, v30, 1, s14
  v_lshrrev_b32 v41, 2, v31
  v_add_u32 v41, 384, v41
  v_min_u32 v31, v31, v41
  v_lshl_add_u32 v31, v31, 1, s14
  v_lshrrev_b32 v42, 2, v32
  v_add_u32 v42, 384, v42
  v_min_u32 v32, v32, v42
  v_lshl_add_u32 v32, v32, 1, s14
  v_lshrrev_b32 v43, 2, v33
  v_add_u32 v43, 384, v43
  v_min_u32 v33, v33, v43
  v_lshl_add_u32 v33, v33, 1, s14
  v_lshrrev_b32 v44, 2, v34
  v_add_u32 v44, 384, v44
  v_min_u32 v34, v34, v44
  v_lshl_add_u32 v34, v34, 1, s14
  v_lshrrev_b32 v45, 2, v35
  v_add_u32 v45, 384, v45
  v_min_u32 v35, v35, v45
  v_lshl_add_u32 v35, v35, 1, s14
  v_lshrrev_b32 v46, 2, v36
  v_add_u32 v46, 384, v46
  v_min_u32 v36, v36, v46
  v_lshl_add_u32 v36, v36, 1, s14
  v_lshrrev_b32 v47, 2, v37
  v_add_u32 v47, 384, v47
  v_min_u32 v37, v37, v47
  v_lshl_add_u32 v37, v37, 1, s14
  v_cvt_pk_f16_f32 v50, v60, v61
  v_cvt_pk_f16_f32 v51, v62, v63
  ds_write_b64 v20, v[50:51]
  s_mul_i32 s20, s19, 11
  s_mul_i32 s21, s19, 10
  s_add_u32 s21, s21, 12
  s_min_u32 s20, s20, s21
  s_cmp_lt_u32 s19, 12
  s_cselect_b32 s21, 3, 2
  s_add_u32 s22, s20, s3
  s_add_u32 s23, s22, 8
  s_waitcnt lgkmcnt(0)
  s_cmp_lg_u32 s3, 5
  s_cbranch_scc1 WT_A
  v_lshlrev_b32 v5, 7, v1
  s_add_u32 s14, s25, 1
  v_add_u32 v20, 8192, v5
  v_add_u32 v21, 16384, v5
  v_add_u32 v22, 24576, v5
  s_mov_b32 s15, 0x40000
WL_A:
  buffer_load_dword v16, v5, s[76:79], 0 offen sc1
  buffer_load_dword v17, v20, s[76:79], 0 offen sc1
  buffer_load_dword v18, v21, s[76:79], 0 offen sc1
  buffer_load_dword v19, v22, s[76:79], 0 offen sc1
  s_waitcnt vmcnt(0)
  v_subrev_u32 v16, s25, v16
  v_subrev_u32 v17, s25, v17
  v_subrev_u32 v18, s25, v18
  v_subrev_u32 v19, s25, v19
  v_and_b32 v52, 0xffffffc7, v16
  v_and_b32 v53, 0xffffffc7, v17
  v_and_b32 v54, 0xffffffc7, v18
  v_and_b32 v55, 0xffffffc7, v19
  v_subrev_u32 v52, 1, v52
  v_subrev_u32 v53, 1, v53
  v_subrev_u32 v54, 1, v54
  v_subrev_u32 v55, 1, v55
  v_max3_u32 v52, v52, v53, v54
  v_max_u32 v52, v52, v55
  v_cmp_lt_u32 vcc, 3, v52
  s_sub_u32 s15, s15, 1
  s_cmp_eq_u32 s15, 0
  s_cbranch_scc1 WD_A
  s_and_b64 vcc, vcc, exec
  s_cbranch_vccz WD_A
  s_sleep 4
  s_branch WL_A
WD_A:
  s_mov_b64 exec, -1
  v_and_b32 v16, 0x38, v16
  v_and_b32 v17, 0x38, v17
  v_and_b32 v18, 0x38, v18
  v_and_b32 v19, 0x38, v19
  v_cmp_ne_u32 s[64:65], s27, v16
  v_cmp_ne_u32 s[66:67], s27, v17
  v_cmp_ne_u32 s[68:69], s27, v18
  v_cmp_ne_u32 s[70:71], s27, v19
  s_lshr_b32 s14, s18, 2
  s_cmp_eq_u32 s14, 1
  s_cselect_b64 s[64:65], s[66:67], s[64:65]
  s_cmp_eq_u32 s14, 2
  s_cselect_b64 s[64:65], s[68:69], s[64:65]
  s_cmp_eq_u32 s14, 3
  s_cselect_b64 s[64:65], s[70:71], s[64:65]
  s_and_b32 s14, s18, 3
  s_lshl_b32 s14, s14, 4
  s_lshr_b64 s[64:65], s[64:65], s14
  s_and_b32 s64, s64, 0xffff
  s_cmp_eq_u32 s64, 0
  s_cselect_b32 s14, 1, 0
  v_mov_b32 v5, s14
  v_mov_b32 v6, 117008
  ds_write_b32 v6, v5
  s_waitcnt lgkmcnt(0)
WT_A:
  s_waitcnt vmcnt(0)
  s_barrier
  s_cmp_lg_u32 s3, 5
  s_cbranch_scc1 SIG_W
  v_mov_b32 v6, 0
  s_add_u32 s14, s25, 2
  s_add_u32 s14, s14, s27
  v_mov_b32 v5, s14
  s_mov_b64 exec, 1
  buffer_store_dword v5, v6, s[76:79], s24 offen sc0 sc1
  s_mov_b64 exec, -1
SIG_W:
  v_mov_b32 v5, 117008
  ds_read_b32 v5, v5
  s_waitcnt lgkmcnt(0)
  v_readfirstlane_b32 s26, v5
  s_add_u32 s44, s42, 0x00000000
  s_addc_u32 s45, s43, 0
  s_and_b32 s45, s45, 0xffff
  s_mov_b32 s46, 0x00210000
  s_mov_b32 s47, 0x00020000
  s_add_u32 s48, s42, 0x00820000
  s_addc_u32 s49, s43, 0
  s_and_b32 s49, s49, 0xffff
  s_mov_b32 s50, 0x00002000
  s_mov_b32 s51, 0x00020000
  s_mov_b32 s60, s28
  s_and_b32 s61, s29, 0xffff
  s_mov_b32 s62, 0x00000400
  s_mov_b32 s63, 0x00020000
  s_add_u32 s64, s42, 0x00280000
  s_addc_u32 s65, s43, 0
  s_and_b32 s65, s65, 0xffff
  s_mov_b32 s66, 0x00210000
  s_mov_b32 s67, 0x00020000
  s_add_u32 s52, s42, 0x00900000
  s_addc_u32 s53, s43, 0
  s_and_b32 s53, s53, 0xffff
  s_mov_b32 s54, 0x002bac00
  s_mov_b32 s55, 0x00020000
  s_mul_i32 s68, s2, 8448
  s_lshl_b32 s69, s2, 2
  s_mul_i32 s70, s2, 8448
  v_lshlrev_b32 v28, 4, v0
  v_mov_b32 v5, 0
  buffer_load_dwordx4 v[8:11], v28, s[44:47], s70 offen sc1
  buffer_load_dwordx4 v[16:19], v28, s[48:51], 0 offen sc1
  buffer_load_dword v29, v5, s[60:63], s69 offen
  v_lshlrev_b32 v7, 4, v1
  ds_read_u16 v40, v30
  ds_read_u16 v41, v31
  ds_read_u16 v42, v32
  ds_read_u16 v43, v33
  ds_read_u16 v44, v34
  ds_read_u16 v45, v35
  ds_read_u16 v46, v36
  ds_read_u16 v47, v37
  s_mul_i32 s14, s4, 4224
  s_add_u32 s14, s14, 108544
  v_lshl_add_u32 v21, v23, 4, s14
  v_mov_b32 v56, 0
  v_mov_b32 v57, 0
  v_mov_b32 v58, 0
  v_mov_b32 v59, 0
  s_waitcnt lgkmcnt(0)
  v_lshl_or_b32 v52, v41, 16, v40
  v_lshl_or_b32 v53, v43, 16, v42
  v_lshl_or_b32 v54, v45, 16, v44
  v_lshl_or_b32 v55, v47, 16, v46
  ds_write_b128 v21, v[52:55]
  v_cmp_gt_u32 vcc, 8, v23
  s_nop 0
  s_and_saveexec_b64 s[30:31], vcc
  ds_write_b128 v21, v[56:59] offset:4096
  s_mov_b64 exec, s[30:31]
  s_mul_i32 s14, s4, 40960
  v_lshl_add_u32 v22, v23, 4, s14
  v_cmp_gt_u32 vcc, 160, v23
  s_nop 0
  s_and_saveexec_b64 s[30:31], vcc
  ds_write_b128 v22, v[56:59] offset:33280
  s_mov_b64 exec, s[30:31]
  s_waitcnt lgkmcnt(0)
  s_barrier
  s_cmp_lg_u32 s3, 5
  s_cbranch_scc1 NOAP
  v_lshlrev_b32 v124, 7, v1
  v_add_u32 v125, 8192, v124
  v_add_u32 v126, 16384, v124
  v_add_u32 v127, 24576, v124
  buffer_load_dword v120, v124, s[76:79], 0 offen sc1
  buffer_load_dword v121, v125, s[76:79], 0 offen sc1
  buffer_load_dword v122, v126, s[76:79], 0 offen sc1
  buffer_load_dword v123, v127, s[76:79], 0 offen sc1
NOAP:
  ds_read_b128 v[32:35], v21 offset:0
  ds_read_b128 v[36:39], v21 offset:16
  s_waitcnt lgkmcnt(0)
  v_mov_b32 v40, v33
  v_mov_b32 v41, v34
  v_mov_b32 v42, v35
  v_mov_b32 v43, v36
  v_mov_b32 v44, v37
  v_mov_b32 v45, v38
  v_alignbit_b32 v48, v33, v32, 16
  v_alignbit_b32 v56, v34, v33, 16
  v_alignbit_b32 v49, v34, v33, 16
  v_alignbit_b32 v57, v35, v34, 16
  v_alignbit_b32 v50, v35, v34, 16
  v_alignbit_b32 v58, v36, v35, 16
  v_alignbit_b32 v51, v36, v35, 16
  v_alignbit_b32 v59, v37, v36, 16
  v_alignbit_b32 v52, v37, v36, 16
  v_alignbit_b32 v60, v38, v37, 16
  v_alignbit_b32 v53, v38, v37, 16
  v_alignbit_b32 v61, v39, v38, 16
  ds_write_b128 v22, v[32:35] offset:0
  ds_write_b128 v22, v[34:37] offset:16640
  ds_write_b128 v22, v[40:43] offset:8320
  ds_write_b128 v22, v[42:45] offset:24960
  ds_write_b128 v22, v[48:51] offset:4160
  ds_write_b128 v22, v[50:53] offset:20800
  ds_write_b128 v22, v[56:59] offset:12480
  ds_write_b128 v22, v[58:61] offset:29120
  v_cmp_gt_u32 vcc, 4, v23
  s_nop 0
  s_and_saveexec_b64 s[30:31], vcc
  s_cbranch_execz NOX
  s_waitcnt lgkmcnt(0)
  ds_read_b128 v[32:35], v21 offset:4096
  ds_read_b128 v[36:39], v21 offset:4112
  s_waitcnt lgkmcnt(0)
  v_mov_b32 v40, v33
  v_mov_b32 v41, v34
  v_mov_b32 v42, v35
  v_mov_b32 v43, v36
  v_mov_b32 v44, v37
  v_mov_b32 v45, v38
  v_alignbit_b32 v48, v33, v32, 16
  v_alignbit_b32 v56, v34, v33, 16
  v_alignbit_b32 v49, v34, v33, 16
  v_alignbit_b32 v57, v35, v34, 16
  v_alignbit_b32 v50, v35, v34, 16
  v_alignbit_b32 v58, v36, v35, 16
  v_alignbit_b32 v51, v36, v35, 16
  v_alignbit_b32 v59, v37, v36, 16
  v_alignbit_b32 v52, v37, v36, 16
  v_alignbit_b32 v60, v38, v37, 16
  v_alignbit_b32 v53, v38, v37, 16
  v_alignbit_b32 v61, v39, v38, 16
  ds_write_b128 v22, v[32:35] offset:4096
  ds_write_b128 v22, v[34:37] offset:20736
  ds_write_b128 v22, v[40:43] offset:12416
  ds_write_b128 v22, v[42:45] offset:29056
  ds_write_b128 v22, v[48:51] offset:8256
  ds_write_b128 v22, v[50:53] offset:24896
  ds_write_b128 v22, v[56:59] offset:16576
  ds_write_b128 v22, v[58:61] offset:33216
NOX:
  s_mov_b64 exec, s[30:31]
  s_waitcnt vmcnt(0)
  v_lshlrev_b32 v64, 16, v16
  v_and_b32 v68, 0xffff0000, v16
  v_lshlrev_b32 v65, 16, v17
  v_and_b32 v69, 0xffff0000, v17
  v_lshlrev_b32 v66, 16, v18
  v_and_b32 v70, 0xffff0000, v18
  v_lshlrev_b32 v67, 16, v19
  v_and_b32 v71, 0xffff0000, v19
  v_rcp_f32 v68, v68
  v_rcp_f32 v69, v69
  v_rcp_f32 v70, v70
  v_rcp_f32 v71, v71
  v_dot2_f32_bf16 v72, v8, s81, v64
  v_dot2_f32_bf16 v73, v8, s82, v64
  v_dot2_f32_bf16 v74, v9, s81, v65
  v_dot2_f32_bf16 v75, v9, s82, v65
  v_dot2_f32_bf16 v76, v10, s81, v66
  v_dot2_f32_bf16 v77, v10, s82, v66
  v_dot2_f32_bf16 v78, v11, s81, v67
  v_dot2_f32_bf16 v79, v11, s82, v67
  v_cvt_pk_bf16_f32 v64, v72, v73
  v_cvt_pk_bf16_f32 v65, v74, v75
  v_cvt_pk_bf16_f32 v66, v76, v77
  v_cvt_pk_bf16_f32 v67, v78, v79
  v_lshlrev_b32 v72, 16, v64
  v_and_b32 v73, 0xffff0000, v64
  v_lshlrev_b32 v74, 16, v65
  v_and_b32 v75, 0xffff0000, v65
  v_lshlrev_b32 v76, 16, v66
  v_and_b32 v77, 0xffff0000, v66
  v_lshlrev_b32 v78, 16, v67
  v_and_b32 v79, 0xffff0000, v67
  v_mul_f32 v72, v72, v68
  v_mul_f32 v73, v73, v68
  v_mul_f32 v74, v74, v69
  v_mul_f32 v75, v75, v69
  v_mul_f32 v76, v76, v70
  v_mul_f32 v77, v77, v70
  v_mul_f32 v78, v78, v71
  v_mul_f32 v79, v79, v71
  v_cvt_pk_bf16_f32 v12, v72, v73
  v_cvt_pk_bf16_f32 v13, v74, v75
  v_cvt_pk_bf16_f32 v14, v76, v77
  v_cvt_pk_bf16_f32 v15, v78, v79
  v_lshlrev_b32 v72, 16, v12
  v_and_b32 v73, 0xffff0000, v12
  v_lshlrev_b32 v74, 16, v13
  v_and_b32 v75, 0xffff0000, v13
  v_lshlrev_b32 v76, 16, v14
  v_and_b32 v77, 0xffff0000, v14
  v_lshlrev_b32 v78, 16, v15
  v_and_b32 v79, 0xffff0000, v15
  v_cvt_pk_f16_f32 v64, v72, v74
  v_cvt_pk_f16_f32 v65, v76, v78
  v_cvt_pk_f16_f32 v66, v73, v75
  v_cvt_pk_f16_f32 v67, v77, v79
  v_lshrrev_b32 v24, 3, v0
  v_mul_u32_u24 v24, 80, v24
  v_and_b32 v25, 7, v0
  v_lshl_add_u32 v24, v25, 3, v24
  v_add_u32 v25, 40960, v24
  ds_write_b64 v24, v[64:65] offset:35840
  ds_write_b64 v25, v[66:67] offset:35840
  v_lshlrev_b32 v27, 4, v1
  s_mul_i32 s60, s22, 16640
  s_mul_i32 s61, s23, 16640
  s_cmp_ge_u32 s3, s21
  s_cselect_b32 s61, 0x7f000000, s61
  s_and_b32 s6, s3, 3
  v_and_b32 v6, 31, v1
  v_lshrrev_b32 v7, 5, v1
  v_and_b32 v26, 7, v6
  v_sub_u32 v26, 7, v26
  v_mul_u32_u24 v26, 4160, v26
  v_lshrrev_b32 v25, 3, v6
  v_sub_u32 v25, 3, v25
  v_add_u32 v25, v25, v7
  v_lshl_add_u32 v26, v25, 4, v26
  s_sub_u32 s7, 3, s6
  s_lshl_b32 s13, s7, 6
  s_add_u32 s13, s13, s14
  v_add_u32 v26, s13, v26
  v_mul_u32_u24 v30, 80, v6
  v_lshl_add_u32 v30, v7, 4, v30
  s_mul_i32 s13, s7, 80
  s_add_u32 s13, s13, s14
  v_add_u32 v30, s13, v30
  v_mul_u32_u24 v31, 144, v6
  v_lshl_add_u32 v31, v7, 4, v31
  s_mul_i32 s13, s6, 9216
  s_add_u32 s13, s13, s14
  v_add_u32 v31, s13, v31
  v_lshrrev_b32 v20, 3, v0
  v_min_u32 v20, 42, v20
  v_mul_u32_u24 v20, 144, v20
  v_add_u32 v20, 128944, v20
  v_and_b32 v21, 7, v0
  v_lshlrev_b32 v21, 4, v21
  v_add_u32 v22, v20, v21
  ds_read_b128 v[32:35], v22
  ds_read_b32 v36, v20 offset:128
  s_add_u32 s56, s42, 0x00c00000
  s_addc_u32 s57, s43, 0
  s_and_b32 s57, s57, 0xffff
  s_mov_b32 s58, 0x00158000
  s_mov_b32 s59, 0x00020000
  v_mov_b32 v37, 0x7f000000
  v_cmp_gt_u32 vcc, 344, v0
  s_waitcnt lgkmcnt(0)
  v_add_u32 v36, v36, v21
  v_cndmask_b32 v36, v37, v36, vcc
  s_cmp_lg_u32 s3, 5
  s_cbranch_scc1 WT_W
  v_subrev_u32 v120, s25, v120
  v_subrev_u32 v121, s25, v121
  v_subrev_u32 v122, s25, v122
  v_subrev_u32 v123, s25, v123
  v_and_b32 v120, 0xffffffc7, v120
  v_and_b32 v121, 0xffffffc7, v121
  v_and_b32 v122, 0xffffffc7, v122
  v_and_b32 v123, 0xffffffc7, v123
  v_subrev_u32 v120, 2, v120
  v_subrev_u32 v121, 2, v121
  v_subrev_u32 v122, 2, v122
  v_subrev_u32 v123, 2, v123
  v_max3_u32 v120, v120, v121, v122
  v_max_u32 v120, v120, v123
  v_cmp_lt_u32 vcc, 2, v120
  s_nop 1
  s_cbranch_vccz WT_W
  s_cmp_lg_u32 s3, 5
  s_cbranch_scc1 WT_W
  v_lshlrev_b32 v5, 7, v1
  s_add_u32 s14, s25, 2
  v_add_u32 v20, 8192, v5
  v_add_u32 v21, 16384, v5
  v_add_u32 v22, 24576, v5
  s_mov_b32 s15, 0x40000
WL_W:
  buffer_load_dword v16, v5, s[76:79], 0 offen sc1
  buffer_load_dword v17, v20, s[76:79], 0 offen sc1
  buffer_load_dword v18, v21, s[76:79], 0 offen sc1
  buffer_load_dword v19, v22, s[76:79], 0 offen sc1
  s_waitcnt vmcnt(0)
  v_subrev_u32 v16, s25, v16
  v_subrev_u32 v17, s25, v17
  v_subrev_u32 v18, s25, v18
  v_subrev_u32 v19, s25, v19
  v_and_b32 v52, 0xffffffc7, v16
  v_and_b32 v53, 0xffffffc7, v17
  v_and_b32 v54, 0xffffffc7, v18
  v_and_b32 v55, 0xffffffc7, v19
  v_subrev_u32 v52, 2, v52
  v_subrev_u32 v53, 2, v53
  v_subrev_u32 v54, 2, v54
  v_subrev_u32 v55, 2, v55
  v_max3_u32 v52, v52, v53, v54
  v_max_u32 v52, v52, v55
  v_cmp_lt_u32 vcc, 2, v52
  s_sub_u32 s15, s15, 1
  s_cmp_eq_u32 s15, 0
  s_cbranch_scc1 WD_W
  s_and_b64 vcc, vcc, exec
  s_cbranch_vccz WD_W
  s_sleep 4
  s_branch WL_W
WD_W:
  s_mov_b64 exec, -1
WT_W:
  buffer_store_dwordx4 v[32:35], v36, s[56:59], 0 offen sc1
  s_barrier
  ds_read_b128 v[32:35], v26 offset:3840
  ds_read_b128 v[36:39], v30 offset:35600
  ds_read_b128 v[40:43], v30 offset:38160
  ds_read_b128 v[44:47], v26 offset:1792
  ds_read_b128 v[48:51], v26 offset:3872
  ds_read_b128 v[52:55], v30 offset:35632
  ds_read_b128 v[56:59], v30 offset:38192
  ds_read_b128 v[60:63], v26 offset:1824
  s_waitcnt lgkmcnt(6)
  v_mfma_f32_32x32x16_f16 v[96:111], v[32:35], v[36:39], 0
  ds_read_b128 v[64:67], v26 offset:3584
  ds_read_b128 v[68:71], v30 offset:35280
  s_waitcnt lgkmcnt(7)
  v_mfma_f32_32x32x16_f16 v[112:127], v[32:35], v[40:43], 0
  ds_read_b128 v[72:75], v30 offset:37840
  ds_read_b128 v[76:79], v26 offset:1536
  buffer_load_dwordx4 a[0:3], v27, s[52:55], s60 offen offset:0 sc1
  s_waitcnt lgkmcnt(8)
  v_mfma_f32_32x32x16_f16 v[112:127], v[44:47], v[36:39], v[112:127]
  ds_read_b128 v[80:83], v26 offset:3616
  ds_read_b128 v[84:87], v30 offset:35312
  s_waitcnt lgkmcnt(8)
  v_mfma_f32_32x32x16_f16 v[96:111], v[48:51], v[52:55], v[96:111]
  ds_read_b128 v[88:91], v30 offset:37872
  ds_read_b128 v[92:95], v26 offset:1568
  s_waitcnt lgkmcnt(9)
  v_mfma_f32_32x32x16_f16 v[112:127], v[48:51], v[56:59], v[112:127]
  buffer_load_dwordx4 a[4:7], v27, s[52:55], s60 offen offset:1024 sc1
  s_waitcnt lgkmcnt(8)
  v_mfma_f32_32x32x16_f16 v[112:127], v[60:63], v[52:55], v[112:127]
  s_waitcnt lgkmcnt(6)
  v_mfma_f32_32x32x16_f16 v[96:111], v[64:67], v[68:71], v[96:111]
  ds_read_b128 v[32:35], v26 offset:3328
  ds_read_b128 v[36:39], v30 offset:34960
  s_waitcnt lgkmcnt(7)
  v_mfma_f32_32x32x16_f16 v[112:127], v[64:67], v[72:75], v[112:127]
  ds_read_b128 v[40:43], v30 offset:37520
  ds_read_b128 v[44:47], v26 offset:1280
  buffer_load_dwordx4 a[8:11], v27, s[52:55], s60 offen offset:2048 sc1
  s_waitcnt lgkmcnt(8)
  v_mfma_f32_32x32x16_f16 v[112:127], v[76:79], v[68:71], v[112:127]
  ds_read_b128 v[48:51], v26 offset:3360
  ds_read_b128 v[52:55], v30 offset:34992
  s_waitcnt lgkmcnt(8)
  v_mfma_f32_32x32x16_f16 v[96:111], v[80:83], v[84:87], v[96:111]
  ds_read_b128 v[56:59], v30 offset:37552
  ds_read_b128 v[60:63], v26 offset:1312
  s_waitcnt lgkmcnt(9)
  v_mfma_f32_32x32x16_f16 v[112:127], v[80:83], v[88:91], v[112:127]
  buffer_load_dwordx4 a[12:15], v27, s[52:55], s60 offen offset:3072 sc1
  s_waitcnt lgkmcnt(8)
  v_mfma_f32_32x32x16_f16 v[112:127], v[92:95], v[84:87], v[112:127]
  s_add_u32 s60, s60, 4096
  s_waitcnt lgkmcnt(6)
  v_mfma_f32_32x32x16_f16 v[96:111], v[32:35], v[36:39], v[96:111]
  ds_read_b128 v[64:67], v26 offset:3072
  ds_read_b128 v[68:71], v30 offset:34640
  s_waitcnt lgkmcnt(7)
  v_mfma_f32_32x32x16_f16 v[112:127], v[32:35], v[40:43], v[112:127]
  ds_read_b128 v[72:75], v30 offset:37200
  ds_read_b128 v[76:79], v26 offset:1024
  buffer_load_dwordx4 a[16:19], v27, s[52:55], s60 offen offset:0 sc1
  s_waitcnt lgkmcnt(8)
  v_mfma_f32_32x32x16_f16 v[112:127], v[44:47], v[36:39], v[112:127]
  ds_read_b128 v[80:83], v26 offset:3104
  ds_read_b128 v[84:87], v30 offset:34672
  s_waitcnt lgkmcnt(8)
  v_mfma_f32_32x32x16_f16 v[96:111], v[48:51], v[52:55], v[96:111]
  ds_read_b128 v[88:91], v30 offset:37232
  ds_read_b128 v[92:95], v26 offset:1056
  s_waitcnt lgkmcnt(9)
  v_mfma_f32_32x32x16_f16 v[112:127], v[48:51], v[56:59], v[112:127]
  buffer_load_dwordx4 a[20:23], v27, s[52:55], s60 offen offset:1024 sc1
  s_waitcnt lgkmcnt(8)
  v_mfma_f32_32x32x16_f16 v[112:127], v[60:63], v[52:55], v[112:127]
  s_waitcnt lgkmcnt(6)
  v_mfma_f32_32x32x16_f16 v[96:111], v[64:67], v[68:71], v[96:111]
  ds_read_b128 v[32:35], v26 offset:2816
  ds_read_b128 v[36:39], v30 offset:34320
  s_waitcnt lgkmcnt(7)
  v_mfma_f32_32x32x16_f16 v[112:127], v[64:67], v[72:75], v[112:127]
  ds_read_b128 v[40:43], v30 offset:36880
  ds_read_b128 v[44:47], v26 offset:768
  buffer_load_dwordx4 a[24:27], v27, s[52:55], s60 offen offset:2048 sc1
  s_waitcnt lgkmcnt(8)
  v_mfma_f32_32x32x16_f16 v[112:127], v[76:79], v[68:71], v[112:127]
  ds_read_b128 v[48:51], v26 offset:2848
  ds_read_b128 v[52:55], v30 offset:34352
  s_waitcnt lgkmcnt(8)
  v_mfma_f32_32x32x16_f16 v[96:111], v[80:83], v[84:87], v[96:111]
  ds_read_b128 v[56:59], v30 offset:36912
  ds_read_b128 v[60:63], v26 offset:800
  s_waitcnt lgkmcnt(9)
  v_mfma_f32_32x32x16_f16 v[112:127], v[80:83], v[88:91], v[112:127]
  buffer_load_dwordx4 a[28:31], v27, s[52:55], s60 offen offset:3072 sc1
  s_waitcnt lgkmcnt(8)
  v_mfma_f32_32x32x16_f16 v[112:127], v[92:95], v[84:87], v[112:127]
  s_add_u32 s60, s60, 4096
  s_waitcnt lgkmcnt(6)
  v_mfma_f32_32x32x16_f16 v[96:111], v[32:35], v[36:39], v[96:111]
  ds_read_b128 v[64:67], v26 offset:2560
  ds_read_b128 v[68:71], v30 offset:34000
  s_waitcnt lgkmcnt(7)
  v_mfma_f32_32x32x16_f16 v[112:127], v[32:35], v[40:43], v[112:127]
  ds_read_b128 v[72:75], v30 offset:36560
  ds_read_b128 v[76:79], v26 offset:512
  buffer_load_dwordx4 a[32:35], v27, s[52:55], s60 offen offset:0 sc1
  s_waitcnt lgkmcnt(8)
  v_mfma_f32_32x32x16_f16 v[112:127], v[44:47], v[36:39], v[112:127]
  ds_read_b128 v[80:83], v26 offset:2592
  ds_read_b128 v[84:87], v30 offset:34032
  s_waitcnt lgkmcnt(8)
  v_mfma_f32_32x32x16_f16 v[96:111], v[48:51], v[52:55], v[96:111]
  ds_read_b128 v[88:91], v30 offset:36592
  ds_read_b128 v[92:95], v26 offset:544
  s_waitcnt lgkmcnt(9)
  v_mfma_f32_32x32x16_f16 v[112:127], v[48:51], v[56:59], v[112:127]
  buffer_load_dwordx4 a[36:39], v27, s[52:55], s60 offen offset:1024 sc1
  s_waitcnt lgkmcnt(8)
  v_mfma_f32_32x32x16_f16 v[112:127], v[60:63], v[52:55], v[112:127]
  s_waitcnt lgkmcnt(6)
  v_mfma_f32_32x32x16_f16 v[96:111], v[64:67], v[68:71], v[96:111]
  ds_read_b128 v[32:35], v26 offset:2304
  ds_read_b128 v[36:39], v30 offset:33680
  s_waitcnt lgkmcnt(7)
  v_mfma_f32_32x32x16_f16 v[112:127], v[64:67], v[72:75], v[112:127]
  ds_read_b128 v[40:43], v30 offset:36240
  ds_read_b128 v[44:47], v26 offset:256
  buffer_load_dwordx4 a[40:43], v27, s[52:55], s60 offen offset:2048 sc1
  s_waitcnt lgkmcnt(8)
  v_mfma_f32_32x32x16_f16 v[112:127], v[76:79], v[68:71], v[112:127]
  ds_read_b128 v[48:51], v26 offset:2336
  ds_read_b128 v[52:55], v30 offset:33712
  s_waitcnt lgkmcnt(8)
  v_mfma_f32_32x32x16_f16 v[96:111], v[80:83], v[84:87], v[96:111]
  ds_read_b128 v[56:59], v30 offset:36272
  ds_read_b128 v[60:63], v26 offset:288
  s_waitcnt lgkmcnt(9)
  v_mfma_f32_32x32x16_f16 v[112:127], v[80:83], v[88:91], v[112:127]
  buffer_load_dwordx4 a[44:47], v27, s[52:55], s60 offen offset:3072 sc1
  s_waitcnt lgkmcnt(8)
  v_mfma_f32_32x32x16_f16 v[112:127], v[92:95], v[84:87], v[112:127]
  s_add_u32 s60, s60, 4096
  s_waitcnt lgkmcnt(6)
  v_mfma_f32_32x32x16_f16 v[96:111], v[32:35], v[36:39], v[96:111]
  ds_read_b128 v[64:67], v26 offset:2048
  ds_read_b128 v[68:71], v30 offset:33360
  s_waitcnt lgkmcnt(7)
  v_mfma_f32_32x32x16_f16 v[112:127], v[32:35], v[40:43], v[112:127]
  ds_read_b128 v[72:75], v30 offset:35920
  ds_read_b128 v[76:79], v26 offset:0
  buffer_load_dwordx4 a[48:51], v27, s[52:55], s60 offen offset:0 sc1
  s_waitcnt lgkmcnt(8)
  v_mfma_f32_32x32x16_f16 v[112:127], v[44:47], v[36:39], v[112:127]
  ds_read_b128 v[80:83], v26 offset:2080
  ds_read_b128 v[84:87], v30 offset:33392
  s_waitcnt lgkmcnt(8)
  v_mfma_f32_32x32x16_f16 v[96:111], v[48:51], v[52:55], v[96:111]
  ds_read_b128 v[88:91], v30 offset:35952
  ds_read_b128 v[92:95], v26 offset:32
  s_waitcnt lgkmcnt(9)
  v_mfma_f32_32x32x16_f16 v[112:127], v[48:51], v[56:59], v[112:127]
  buffer_load_dwordx4 a[52:55], v27, s[52:55], s60 offen offset:1024 sc1
  s_waitcnt lgkmcnt(8)
  v_mfma_f32_32x32x16_f16 v[112:127], v[60:63], v[52:55], v[112:127]
  s_waitcnt lgkmcnt(6)
  v_mfma_f32_32x32x16_f16 v[96:111], v[64:67], v[68:71], v[96:111]
  s_waitcnt lgkmcnt(5)
  v_mfma_f32_32x32x16_f16 v[112:127], v[64:67], v[72:75], v[112:127]
  buffer_load_dwordx4 a[56:59], v27, s[52:55], s60 offen offset:2048 sc1
  s_waitcnt lgkmcnt(4)
  v_mfma_f32_32x32x16_f16 v[112:127], v[76:79], v[68:71], v[112:127]
  s_waitcnt lgkmcnt(2)
  v_mfma_f32_32x32x16_f16 v[96:111], v[80:83], v[84:87], v[96:111]
  s_waitcnt lgkmcnt(1)
  v_mfma_f32_32x32x16_f16 v[112:127], v[80:83], v[88:91], v[112:127]
  buffer_load_dwordx4 a[60:63], v27, s[52:55], s60 offen offset:3072 sc1
  s_waitcnt lgkmcnt(0)
  v_mfma_f32_32x32x16_f16 v[112:127], v[92:95], v[84:87], v[112:127]
  s_barrier
  s_nop 5
  ds_write_b128 v31, v[96:99] offset:0
  ds_write_b128 v31, v[100:103] offset:32
  ds_write_b128 v31, v[104:107] offset:64
  ds_write_b128 v31, v[108:111] offset:96
  s_nop 0
  ds_write_b128 v31, v[112:115] offset:4608
  ds_write_b128 v31, v[116:119] offset:4640
  ds_write_b128 v31, v[120:123] offset:4672
  ds_write_b128 v31, v[124:127] offset:4704
  v_lshrrev_b32 v6, 3, v0
  v_mul_u32_u24 v6, 144, v6
  v_and_b32 v7, 7, v0
  v_lshl_add_u32 v6, v7, 4, v6
  v_add_u32 v7, 40960, v6
  v_mov_b32 v20, 116992
  v_lshlrev_b32 v22, 16, v29
  v_and_b32 v23, 0xffff0000, v29
  s_waitcnt lgkmcnt(0)
  s_barrier
  ds_read_b64 v[24:25], v20
  ds_read_b128 v[32:35], v6 offset:0
  ds_read_b128 v[36:39], v6 offset:9216
  ds_read_b128 v[40:43], v6 offset:18432
  ds_read_b128 v[44:47], v6 offset:27648
  ds_read_b128 v[48:51], v7 offset:0
  ds_read_b128 v[52:55], v7 offset:9216
  ds_read_b128 v[56:59], v7 offset:18432
  ds_read_b128 v[60:63], v7 offset:27648
  v_lshlrev_b32 v64, 16, v12
  v_and_b32 v65, 0xffff0000, v12
  v_lshlrev_b32 v66, 16, v13
  v_and_b32 v67, 0xffff0000, v13
  v_lshlrev_b32 v68, 16, v14
  v_and_b32 v69, 0xffff0000, v14
  v_lshlrev_b32 v70, 16, v15
  v_and_b32 v71, 0xffff0000, v15
  v_mul_f32 v64, v64, v22
  v_mul_f32 v65, v65, v23
  v_mul_f32 v66, v66, v22
  v_mul_f32 v67, v67, v23
  v_mul_f32 v68, v68, v22
  v_mul_f32 v69, v69, v23
  v_mul_f32 v70, v70, v22
  v_mul_f32 v71, v71, v23
  v_cvt_pk_bf16_f32 v72, v64, v65
  v_cvt_pk_bf16_f32 v73, v66, v67
  v_cvt_pk_bf16_f32 v74, v68, v69
  v_cvt_pk_bf16_f32 v75, v70, v71
  v_lshlrev_b32 v64, 16, v72
  v_and_b32 v65, 0xffff0000, v72
  v_lshlrev_b32 v66, 16, v73
  v_and_b32 v67, 0xffff0000, v73
  v_lshlrev_b32 v68, 16, v74
  v_and_b32 v69, 0xffff0000, v74
  v_lshlrev_b32 v70, 16, v75
  v_and_b32 v71, 0xffff0000, v75
  s_waitcnt lgkmcnt(0)
  v_add_f32 v32, v32, v36
  v_add_f32 v40, v40, v44
  v_add_f32 v33, v33, v37
  v_add_f32 v41, v41, v45
  v_add_f32 v34, v34, v38
  v_add_f32 v42, v42, v46
  v_add_f32 v35, v35, v39
  v_add_f32 v43, v43, v47
  v_add_f32 v32, v32, v40
  v_add_f32 v33, v33, v41
  v_add_f32 v34, v34, v42
  v_add_f32 v35, v35, v43
  v_mul_f32 v32, v32, v24
  v_mul_f32 v33, v33, v24
  v_mul_f32 v34, v34, v24
  v_mul_f32 v35, v35, v24
  v_add_f32 v48, v48, v52
  v_add_f32 v56, v56, v60
  v_add_f32 v49, v49, v53
  v_add_f32 v57, v57, v61
  v_add_f32 v50, v50, v54
  v_add_f32 v58, v58, v62
  v_add_f32 v51, v51, v55
  v_add_f32 v59, v59, v63
  v_add_f32 v48, v48, v56
  v_add_f32 v49, v49, v57
  v_add_f32 v50, v50, v58
  v_add_f32 v51, v51, v59
  v_mul_f32 v48, v48, v25
  v_mul_f32 v49, v49, v25
  v_mul_f32 v50, v50, v25
  v_mul_f32 v51, v51, v25
  v_cvt_pk_bf16_f32 v72, v32, v48
  v_cvt_pk_bf16_f32 v73, v33, v49
  v_cvt_pk_bf16_f32 v74, v34, v50
  v_cvt_pk_bf16_f32 v75, v35, v51
  v_lshlrev_b32 v32, 16, v72
  v_and_b32 v33, 0xffff0000, v72
  v_lshlrev_b32 v34, 16, v73
  v_and_b32 v35, 0xffff0000, v73
  v_lshlrev_b32 v36, 16, v74
  v_and_b32 v37, 0xffff0000, v74
  v_lshlrev_b32 v38, 16, v75
  v_and_b32 v39, 0xffff0000, v75
  v_add_f32 v64, v64, v32
  v_add_f32 v65, v65, v33
  v_add_f32 v66, v66, v34
  v_add_f32 v67, v67, v35
  v_add_f32 v68, v68, v36
  v_add_f32 v69, v69, v37
  v_add_f32 v70, v70, v38
  v_add_f32 v71, v71, v39
  v_cvt_pk_bf16_f32 v72, v64, v65
  v_cvt_pk_bf16_f32 v73, v66, v67
  v_cvt_pk_bf16_f32 v74, v68, v69
  v_cvt_pk_bf16_f32 v75, v70, v71
  v_lshlrev_b32 v64, 16, v72
  v_and_b32 v65, 0xffff0000, v72
  v_lshlrev_b32 v32, 16, v8
  v_and_b32 v33, 0xffff0000, v8
  v_lshlrev_b32 v66, 16, v73
  v_and_b32 v67, 0xffff0000, v73
  v_lshlrev_b32 v34, 16, v9
  v_and_b32 v35, 0xffff0000, v9
  v_lshlrev_b32 v68, 16, v74
  v_and_b32 v69, 0xffff0000, v74
  v_lshlrev_b32 v36, 16, v10
  v_and_b32 v37, 0xffff0000, v10
  v_lshlrev_b32 v70, 16, v75
  v_and_b32 v71, 0xffff0000, v75
  v_lshlrev_b32 v38, 16, v11
  v_and_b32 v39, 0xffff0000, v11
  v_add_f32 v64, v64, v32
  v_add_f32 v65, v65, v33
  v_add_f32 v66, v66, v34
  v_add_f32 v67, v67, v35
  v_add_f32 v68, v68, v36
  v_add_f32 v69, v69, v37
  v_add_f32 v70, v70, v38
  v_add_f32 v71, v71, v39
  v_cvt_pk_bf16_f32 v72, v64, v65
  v_cvt_pk_bf16_f32 v73, v66, v67
  v_cvt_pk_bf16_f32 v74, v68, v69
  v_cvt_pk_bf16_f32 v75, v70, v71
  buffer_store_dwordx4 v[72:75], v28, s[64:67], s68 offen sc1
  s_mov_b32 s6, s18
  s_mov_b32 s7, s19
  s_mov_b32 s9, s21
  s_mov_b32 s10, s22
  s_mov_b32 s11, s23
  s_add_u32 s44, s42, 0x00280000
  s_addc_u32 s45, s43, 0
  s_and_b32 s45, s45, 0xffff
  s_mov_b32 s46, 0x00210000
  s_mov_b32 s47, 0x00020000
  s_add_u32 s56, s42, 0x00e00000
  s_addc_u32 s57, s43, 0
  s_and_b32 s57, s57, 0xffff
  s_mov_b32 s58, 0x00560000
  s_mov_b32 s59, 0x00020000
  s_add_u32 s48, s42, 0x00c00000
  s_addc_u32 s49, s43, 0
  s_and_b32 s49, s49, 0xffff
  s_mov_b32 s50, 0x00158000
  s_mov_b32 s51, 0x00020000
  v_and_b32 v3, 31, v1
  v_lshrrev_b32 v4, 5, v1
  v_lshl_add_u32 v5, v2, 1, v4
  v_mul_u32_u24 v8, 33792, v5
  v_lshl_add_u32 v8, v3, 4, v8
  s_lshl_b32 s12, s6, 9
  v_add_u32 v8, s12, v8
  v_mov_b32 v62, v5
  s_and_b32 s13, s2, 15
  s_lshl_b32 s13, s13, 2
  s_waitcnt vmcnt(0)
  s_barrier
  s_cmp_lg_u32 s3, 5
  s_cbranch_scc1 SIG_B
  v_mov_b32 v6, 0
  s_add_u32 s14, s25, 3
  s_add_u32 s14, s14, s27
  v_mov_b32 v5, s14
  s_mov_b64 exec, 1
  buffer_store_dword v5, v6, s[76:79], s24 offen sc0 sc1
  s_mov_b64 exec, -1
SIG_B:
  s_cmp_ge_u32 s3, s21
  s_cbranch_scc1 NOWB
  v_lshlrev_b32 v7, 4, v1
  s_mul_i32 s14, s23, 16640
  buffer_load_dwordx4 a[64:67], v7, s[52:55], s14 offen offset:0 sc1
  buffer_load_dwordx4 a[68:71], v7, s[52:55], s14 offen offset:1024 sc1
  buffer_load_dwordx4 a[72:75], v7, s[52:55], s14 offen offset:2048 sc1
  buffer_load_dwordx4 a[76:79], v7, s[52:55], s14 offen offset:3072 sc1
  s_add_u32 s14, s14, 4096
  buffer_load_dwordx4 a[80:83], v7, s[52:55], s14 offen offset:0 sc1
  buffer_load_dwordx4 a[84:87], v7, s[52:55], s14 offen offset:1024 sc1
  buffer_load_dwordx4 a[88:91], v7, s[52:55], s14 offen offset:2048 sc1
  buffer_load_dwordx4 a[92:95], v7, s[52:55], s14 offen offset:3072 sc1
  s_add_u32 s14, s14, 4096
  buffer_load_dwordx4 a[96:99], v7, s[52:55], s14 offen offset:0 sc1
  buffer_load_dwordx4 a[100:103], v7, s[52:55], s14 offen offset:1024 sc1
  buffer_load_dwordx4 a[104:107], v7, s[52:55], s14 offen offset:2048 sc1
  buffer_load_dwordx4 a[108:111], v7, s[52:55], s14 offen offset:3072 sc1
  s_add_u32 s14, s14, 4096
  buffer_load_dwordx4 a[112:115], v7, s[52:55], s14 offen offset:0 sc1
  buffer_load_dwordx4 a[116:119], v7, s[52:55], s14 offen offset:1024 sc1
  buffer_load_dwordx4 a[120:123], v7, s[52:55], s14 offen offset:2048 sc1
  buffer_load_dwordx4 a[124:127], v7, s[52:55], s14 offen offset:3072 sc1
NOWB:
  s_cmp_lg_u32 s3, 5
  s_cbranch_scc1 WT_B
  v_lshlrev_b32 v5, 7, v1
  s_add_u32 s14, s25, 3
  v_add_u32 v20, 8192, v5
  v_add_u32 v21, 16384, v5
  v_add_u32 v22, 24576, v5
  s_mov_b32 s15, 0x40000
WL_B:
  buffer_load_dword v16, v5, s[76:79], 0 offen sc1
  buffer_load_dword v17, v20, s[76:79], 0 offen sc1
  buffer_load_dword v18, v21, s[76:79], 0 offen sc1
  buffer_load_dword v19, v22, s[76:79], 0 offen sc1
  s_waitcnt vmcnt(0)
  v_subrev_u32 v16, s25, v16
  v_subrev_u32 v17, s25, v17
  v_subrev_u32 v18, s25, v18
  v_subrev_u32 v19, s25, v19
  v_and_b32 v52, 0xffffffc7, v16
  v_and_b32 v53, 0xffffffc7, v17
  v_and_b32 v54, 0xffffffc7, v18
  v_and_b32 v55, 0xffffffc7, v19
  v_subrev_u32 v52, 3, v52
  v_subrev_u32 v53, 3, v53
  v_subrev_u32 v54, 3, v54
  v_subrev_u32 v55, 3, v55
  v_max3_u32 v52, v52, v53, v54
  v_max_u32 v52, v52, v55
  v_cmp_lt_u32 vcc, 1, v52
  s_sub_u32 s15, s15, 1
  s_cmp_eq_u32 s15, 0
  s_cbranch_scc1 WD_B
  s_and_b64 vcc, vcc, exec
  s_cbranch_vccz WD_B
  s_sleep 4
  s_branch WL_B
WD_B:
  s_mov_b64 exec, -1
WT_B:
  s_barrier
  s_mov_b32 s13, 0
  buffer_load_dwordx4 v[64:67], v8, s[44:47], s13 offen sc1
  s_mov_b32 s13, 8448
  buffer_load_dwordx4 v[68:71], v8, s[44:47], s13 offen sc1
  s_mov_b32 s13, 16896
  buffer_load_dwordx4 v[72:75], v8, s[44:47], s13 offen sc1
  s_mov_b32 s13, 25344
  buffer_load_dwordx4 v[76:79], v8, s[44:47], s13 offen sc1
  s_mov_b32 s13, 540672
  buffer_load_dwordx4 v[80:83], v8, s[44:47], s13 offen sc1
  s_mov_b32 s13, 549120
  buffer_load_dwordx4 v[84:87], v8, s[44:47], s13 offen sc1
  s_mov_b32 s13, 557568
  buffer_load_dwordx4 v[88:91], v8, s[44:47], s13 offen sc1
  s_mov_b32 s13, 566016
  buffer_load_dwordx4 v[92:95], v8, s[44:47], s13 offen sc1
  s_mov_b32 s13, 1081344
  buffer_load_dwordx4 v[96:99], v8, s[44:47], s13 offen sc1
  s_mov_b32 s13, 1089792
  buffer_load_dwordx4 v[100:103], v8, s[44:47], s13 offen sc1
  s_mov_b32 s13, 1098240
  buffer_load_dwordx4 v[104:107], v8, s[44:47], s13 offen sc1
  s_mov_b32 s13, 1106688
  buffer_load_dwordx4 v[108:111], v8, s[44:47], s13 offen sc1
  s_mov_b32 s13, 1622016
  buffer_load_dwordx4 v[112:115], v8, s[44:47], s13 offen sc1
  s_mov_b32 s13, 1630464
  buffer_load_dwordx4 v[116:119], v8, s[44:47], s13 offen sc1
  s_mov_b32 s13, 1638912
  buffer_load_dwordx4 v[120:123], v8, s[44:47], s13 offen sc1
  s_mov_b32 s13, 1647360
  buffer_load_dwordx4 v[124:127], v8, s[44:47], s13 offen sc1
  v_mov_b32 v5, v62
  s_and_b32 s4, s7, 1
  s_lshl_b32 s5, s6, 1
  s_add_u32 s5, s5, s4
  s_lshr_b32 s4, s7, 1
  s_mul_i32 s8, s4, 176128
  s_lshl_b32 s12, s3, 10
  s_add_u32 s8, s8, s12
  s_add_u32 s60, s8, 0
  s_add_u32 s61, s8, 44032
  s_add_u32 s62, s8, 88064
  s_add_u32 s63, s8, 132096
  s_mul_i32 s8, s5, 176128
  s_add_u32 s8, s8, s12
  s_add_u32 s64, s8, 0
  s_add_u32 s65, s8, 44032
  s_add_u32 s66, s8, 88064
  s_add_u32 s67, s8, 132096
  v_lshlrev_b32 v48, 4, v3
  v_lshl_add_u32 v49, v2, 9, v48
  s_waitcnt vmcnt(12)
  v_dot2_f32_bf16 v8, v64, s80, 0
  v_dot2_f32_bf16 v9, v65, s80, 0
  v_dot2_f32_bf16 v10, v66, s80, 0
  v_dot2_f32_bf16 v11, v67, s80, 0
  v_dot2_f32_bf16 v8, v68, s80, v8
  v_dot2_f32_bf16 v9, v69, s80, v9
  v_dot2_f32_bf16 v10, v70, s80, v10
  v_dot2_f32_bf16 v11, v71, s80, v11
  v_dot2_f32_bf16 v8, v72, s80, v8
  v_dot2_f32_bf16 v9, v73, s80, v9
  v_dot2_f32_bf16 v10, v74, s80, v10
  v_dot2_f32_bf16 v11, v75, s80, v11
  v_dot2_f32_bf16 v8, v76, s80, v8
  v_dot2_f32_bf16 v9, v77, s80, v9
  v_dot2_f32_bf16 v10, v78, s80, v10
  v_dot2_f32_bf16 v11, v79, s80, v11
  s_waitcnt vmcnt(8)
  v_dot2_f32_bf16 v8, v80, s80, v8
  v_dot2_f32_bf16 v9, v81, s80, v9
  v_dot2_f32_bf16 v10, v82, s80, v10
  v_dot2_f32_bf16 v11, v83, s80, v11
  v_dot2_f32_bf16 v8, v84, s80, v8
  v_dot2_f32_bf16 v9, v85, s80, v9
  v_dot2_f32_bf16 v10, v86, s80, v10
  v_dot2_f32_bf16 v11, v87, s80, v11
  v_dot2_f32_bf16 v8, v88, s80, v8
  v_dot2_f32_bf16 v9, v89, s80, v9
  v_dot2_f32_bf16 v10, v90, s80, v10
  v_dot2_f32_bf16 v11, v91, s80, v11
  v_dot2_f32_bf16 v8, v92, s80, v8
  v_dot2_f32_bf16 v9, v93, s80, v9
  v_dot2_f32_bf16 v10, v94, s80, v10
  v_dot2_f32_bf16 v11, v95, s80, v11
  s_waitcnt vmcnt(4)
  v_dot2_f32_bf16 v8, v96, s80, v8
  v_dot2_f32_bf16 v9, v97, s80, v9
  v_dot2_f32_bf16 v10, v98, s80, v10
  v_dot2_f32_bf16 v11, v99, s80, v11
  v_dot2_f32_bf16 v8, v100, s80, v8
  v_dot2_f32_bf16 v9, v101, s80, v9
  v_dot2_f32_bf16 v10, v102, s80, v10
  v_dot2_f32_bf16 v11, v103, s80, v11
  v_dot2_f32_bf16 v8, v104, s80, v8
  v_dot2_f32_bf16 v9, v105, s80, v9
  v_dot2_f32_bf16 v10, v106, s80, v10
  v_dot2_f32_bf16 v11, v107, s80, v11
  v_dot2_f32_bf16 v8, v108, s80, v8
  v_dot2_f32_bf16 v9, v109, s80, v9
  v_dot2_f32_bf16 v10, v110, s80, v10
  v_dot2_f32_bf16 v11, v111, s80, v11
  s_waitcnt vmcnt(0)
  v_dot2_f32_bf16 v8, v112, s80, v8
  v_dot2_f32_bf16 v9, v113, s80, v9
  v_dot2_f32_bf16 v10, v114, s80, v10
  v_dot2_f32_bf16 v11, v115, s80, v11
  v_dot2_f32_bf16 v8, v116, s80, v8
  v_dot2_f32_bf16 v9, v117, s80, v9
  v_dot2_f32_bf16 v10, v118, s80, v10
  v_dot2_f32_bf16 v11, v119, s80, v11
  v_dot2_f32_bf16 v8, v120, s80, v8
  v_dot2_f32_bf16 v9, v121, s80, v9
  v_dot2_f32_bf16 v10, v122, s80, v10
  v_dot2_f32_bf16 v11, v123, s80, v11
  v_dot2_f32_bf16 v8, v124, s80, v8
  v_dot2_f32_bf16 v9, v125, s80, v9
  v_dot2_f32_bf16 v10, v126, s80, v10
  v_dot2_f32_bf16 v11, v127, s80, v11
  v_mov_b32 v12, v8
  v_mov_b32 v13, v9
  v_mov_b32 v14, v10
  v_mov_b32 v15, v11
  v_permlane32_swap_b32 v8, v12
  v_permlane32_swap_b32 v9, v13
  v_permlane32_swap_b32 v10, v14
  v_permlane32_swap_b32 v11, v15
  v_add_f32 v8, v8, v12
  v_add_f32 v9, v9, v13
  v_add_f32 v10, v10, v14
  v_add_f32 v11, v11, v15
  v_add_u32 v50, 140288, v49
  ds_write_b128 v50, v[8:11]
  s_lshr_b32 s14, s3, 2
  s_and_b32 s15, s4, 1
  s_cmp_lg_u32 s14, s15
  s_cbranch_scc1 NOHR
  s_lshr_b32 s14, s4, 1
  s_cmp_lg_u32 s14, 0
  s_cbranch_scc1 HR1
  v_mov_b32 v16, v64
  v_mov_b32 v17, v68
  v_mov_b32 v18, v72
  v_mov_b32 v19, v76
  v_mov_b32 v20, v65
  v_mov_b32 v21, v69
  v_mov_b32 v22, v73
  v_mov_b32 v23, v77
  v_mov_b32 v24, v66
  v_mov_b32 v25, v70
  v_mov_b32 v26, v74
  v_mov_b32 v27, v78
  v_mov_b32 v28, v67
  v_mov_b32 v29, v71
  v_mov_b32 v30, v75
  v_mov_b32 v31, v79
  s_branch HRS
HR1:
  s_cmp_lg_u32 s14, 1
  s_cbranch_scc1 HR2
  v_mov_b32 v16, v80
  v_mov_b32 v17, v84
  v_mov_b32 v18, v88
  v_mov_b32 v19, v92
  v_mov_b32 v20, v81
  v_mov_b32 v21, v85
  v_mov_b32 v22, v89
  v_mov_b32 v23, v93
  v_mov_b32 v24, v82
  v_mov_b32 v25, v86
  v_mov_b32 v26, v90
  v_mov_b32 v27, v94
  v_mov_b32 v28, v83
  v_mov_b32 v29, v87
  v_mov_b32 v30, v91
  v_mov_b32 v31, v95
  s_branch HRS
HR2:
  s_cmp_lg_u32 s14, 2
  s_cbranch_scc1 HR3
  v_mov_b32 v16, v96
  v_mov_b32 v17, v100
  v_mov_b32 v18, v104
  v_mov_b32 v19, v108
  v_mov_b32 v20, v97
  v_mov_b32 v21, v101
  v_mov_b32 v22, v105
  v_mov_b32 v23, v109
  v_mov_b32 v24, v98
  v_mov_b32 v25, v102
  v_mov_b32 v26, v106
  v_mov_b32 v27, v110
  v_mov_b32 v28, v99
  v_mov_b32 v29, v103
  v_mov_b32 v30, v107
  v_mov_b32 v31, v111
  s_branch HRS
HR3:
  v_mov_b32 v16, v112
  v_mov_b32 v17, v116
  v_mov_b32 v18, v120
  v_mov_b32 v19, v124
  v_mov_b32 v20, v113
  v_mov_b32 v21, v117
  v_mov_b32 v22, v121
  v_mov_b32 v23, v125
  v_mov_b32 v24, v114
  v_mov_b32 v25, v118
  v_mov_b32 v26, v122
  v_mov_b32 v27, v126
  v_mov_b32 v28, v115
  v_mov_b32 v29, v119
  v_mov_b32 v30, v123
  v_mov_b32 v31, v127
HRS:
  v_and_b32 v50, 15, v3
  v_mul_u32_u24 v50, 576, v50
  v_and_b32 v51, 7, v5
  v_lshl_add_u32 v50, v51, 4, v50
  v_add_u32 v50, 148992, v50
  v_lshrrev_b32 v51, 4, v3
  s_and_b32 s15, s7, 1
  v_cmp_eq_u32 vcc, s15, v51
  s_nop 0
  s_and_saveexec_b64 s[30:31], vcc
  ds_write_b128 v50, v[16:19] offset:0
  ds_write_b128 v50, v[20:23] offset:144
  ds_write_b128 v50, v[24:27] offset:288
  ds_write_b128 v50, v[28:31] offset:432
  s_mov_b64 exec, s[30:31]
NOHR:
  s_waitcnt lgkmcnt(0)
  s_barrier
  v_add_u32 v51, 140288, v48
  ds_read_b128 v[16:19], v51 offset:0
  ds_read_b128 v[20:23], v51 offset:512
  ds_read_b128 v[24:27], v51 offset:1024
  ds_read_b128 v[28:31], v51 offset:1536
  ds_read_b128 v[32:35], v51 offset:2048
  ds_read_b128 v[36:39], v51 offset:2560
  ds_read_b128 v[40:43], v51 offset:3072
  ds_read_b128 v[44:47], v51 offset:3584
  s_waitcnt lgkmcnt(0)
  v_add_f32 v16, v16, v32
  v_add_f32 v17, v17, v33
  v_add_f32 v18, v18, v34
  v_add_f32 v19, v19, v35
  v_add_f32 v20, v20, v36
  v_add_f32 v21, v21, v37
  v_add_f32 v22, v22, v38
  v_add_f32 v23, v23, v39
  v_add_f32 v24, v24, v40
  v_add_f32 v25, v25, v41
  v_add_f32 v26, v26, v42
  v_add_f32 v27, v27, v43
  v_add_f32 v28, v28, v44
  v_add_f32 v29, v29, v45
  v_add_f32 v30, v30, v46
  v_add_f32 v31, v31, v47
  v_add_f32 v16, v16, v24
  v_add_f32 v17, v17, v25
  v_add_f32 v18, v18, v26
  v_add_f32 v19, v19, v27
  v_add_f32 v20, v20, v28
  v_add_f32 v21, v21, v29
  v_add_f32 v22, v22, v30
  v_add_f32 v23, v23, v31
  v_add_f32 v16, v16, v20
  v_add_f32 v17, v17, v21
  v_add_f32 v18, v18, v22
  v_add_f32 v19, v19, v23
  v_mov_b32 v8, v16
  v_mov_b32 v9, v17
  v_mov_b32 v10, v18
  v_mov_b32 v11, v19
  v_mul_f32 v8, 0xbb000000, v8
  v_mul_f32 v9, 0xbb000000, v9
  v_mul_f32 v10, 0xbb000000, v10
  v_mul_f32 v11, 0xbb000000, v11
  v_cvt_pk_bf16_f32 v12, v8, v9
  v_cvt_pk_bf16_f32 v14, v10, v11
  v_lshlrev_b32 v52, 16, v12
  v_and_b32 v53, 0xffff0000, v12
  v_lshlrev_b32 v54, 16, v14
  v_and_b32 v55, 0xffff0000, v14
  v_sub_f32 v56, v52, v8
  v_sub_f32 v57, v53, v9
  v_sub_f32 v58, v54, v10
  v_sub_f32 v59, v55, v11
  v_mul_u32_u24 v50, 4384, v3
  v_lshl_add_u32 v50, v5, 4, v50
  v_mov_b32 v8, 0
  v_mov_b32 v9, 0
  v_mov_b32 v10, 0
  v_mov_b32 v11, 0
  v_mov_b32 v12, 0
  v_mov_b32 v13, 0
  v_mov_b32 v14, 0
  v_mov_b32 v15, 0
  v_dot2_f32_bf16 v16, v64, s81, v52
  v_dot2_f32_bf16 v17, v64, s82, v52
  v_dot2_f32_bf16 v18, v68, s81, v52
  v_dot2_f32_bf16 v19, v68, s82, v52
  v_dot2_f32_bf16 v20, v72, s81, v52
  v_dot2_f32_bf16 v21, v72, s82, v52
  v_dot2_f32_bf16 v22, v76, s81, v52
  v_dot2_f32_bf16 v23, v76, s82, v52
  v_dot2_f32_bf16 v24, v65, s81, v53
  v_dot2_f32_bf16 v25, v65, s82, v53
  v_dot2_f32_bf16 v26, v69, s81, v53
  v_dot2_f32_bf16 v27, v69, s82, v53
  v_dot2_f32_bf16 v28, v73, s81, v53
  v_dot2_f32_bf16 v29, v73, s82, v53
  v_dot2_f32_bf16 v30, v77, s81, v53
  v_dot2_f32_bf16 v31, v77, s82, v53
  v_pk_fma_f32 v[8:9], v[16:17], v[16:17], v[8:9]
  v_cvt_pk_bf16_f32 v32, v16, v17
  v_pk_fma_f32 v[8:9], v[18:19], v[18:19], v[8:9]
  v_cvt_pk_bf16_f32 v33, v18, v19
  v_pk_fma_f32 v[8:9], v[20:21], v[20:21], v[8:9]
  v_cvt_pk_bf16_f32 v34, v20, v21
  v_pk_fma_f32 v[8:9], v[22:23], v[22:23], v[8:9]
  v_cvt_pk_bf16_f32 v35, v22, v23
  v_pk_fma_f32 v[10:11], v[24:25], v[24:25], v[10:11]
  v_cvt_pk_bf16_f32 v36, v24, v25
  v_pk_fma_f32 v[10:11], v[26:27], v[26:27], v[10:11]
  v_cvt_pk_bf16_f32 v37, v26, v27
  v_pk_fma_f32 v[10:11], v[28:29], v[28:29], v[10:11]
  v_cvt_pk_bf16_f32 v38, v28, v29
  v_pk_fma_f32 v[10:11], v[30:31], v[30:31], v[10:11]
  v_cvt_pk_bf16_f32 v39, v30, v31
  ds_write_b128 v50, v[32:35] offset:0
  ds_write_b128 v50, v[36:39] offset:1088
  v_dot2_f32_bf16 v16, v66, s81, v54
  v_dot2_f32_bf16 v17, v66, s82, v54
  v_dot2_f32_bf16 v18, v70, s81, v54
  v_dot2_f32_bf16 v19, v70, s82, v54
  v_dot2_f32_bf16 v20, v74, s81, v54
  v_dot2_f32_bf16 v21, v74, s82, v54
  v_dot2_f32_bf16 v22, v78, s81, v54
  v_dot2_f32_bf16 v23, v78, s82, v54
  v_dot2_f32_bf16 v24, v67, s81, v55
  v_dot2_f32_bf16 v25, v67, s82, v55
  v_dot2_f32_bf16 v26, v71, s81, v55
  v_dot2_f32_bf16 v27, v71, s82, v55
  v_dot2_f32_bf16 v28, v75, s81, v55
  v_dot2_f32_bf16 v29, v75, s82, v55
  v_dot2_f32_bf16 v30, v79, s81, v55
  v_dot2_f32_bf16 v31, v79, s82, v55
  v_pk_fma_f32 v[12:13], v[16:17], v[16:17], v[12:13]
  v_cvt_pk_bf16_f32 v40, v16, v17
  v_pk_fma_f32 v[12:13], v[18:19], v[18:19], v[12:13]
  v_cvt_pk_bf16_f32 v41, v18, v19
  v_pk_fma_f32 v[12:13], v[20:21], v[20:21], v[12:13]
  v_cvt_pk_bf16_f32 v42, v20, v21
  v_pk_fma_f32 v[12:13], v[22:23], v[22:23], v[12:13]
  v_cvt_pk_bf16_f32 v43, v22, v23
  v_pk_fma_f32 v[14:15], v[24:25], v[24:25], v[14:15]
  v_cvt_pk_bf16_f32 v44, v24, v25
  v_pk_fma_f32 v[14:15], v[26:27], v[26:27], v[14:15]
  v_cvt_pk_bf16_f32 v45, v26, v27
  v_pk_fma_f32 v[14:15], v[28:29], v[28:29], v[14:15]
  v_cvt_pk_bf16_f32 v46, v28, v29
  v_pk_fma_f32 v[14:15], v[30:31], v[30:31], v[14:15]
  v_cvt_pk_bf16_f32 v47, v30, v31
  ds_write_b128 v50, v[40:43] offset:2176
  ds_write_b128 v50, v[44:47] offset:3264
  v_dot2_f32_bf16 v16, v80, s81, v52
  v_dot2_f32_bf16 v17, v80, s82, v52
  v_dot2_f32_bf16 v18, v84, s81, v52
  v_dot2_f32_bf16 v19, v84, s82, v52
  v_dot2_f32_bf16 v20, v88, s81, v52
  v_dot2_f32_bf16 v21, v88, s82, v52
  v_dot2_f32_bf16 v22, v92, s81, v52
  v_dot2_f32_bf16 v23, v92, s82, v52
  v_dot2_f32_bf16 v24, v81, s81, v53
  v_dot2_f32_bf16 v25, v81, s82, v53
  v_dot2_f32_bf16 v26, v85, s81, v53
  v_dot2_f32_bf16 v27, v85, s82, v53
  v_dot2_f32_bf16 v28, v89, s81, v53
  v_dot2_f32_bf16 v29, v89, s82, v53
  v_dot2_f32_bf16 v30, v93, s81, v53
  v_dot2_f32_bf16 v31, v93, s82, v53
  v_pk_fma_f32 v[8:9], v[16:17], v[16:17], v[8:9]
  v_cvt_pk_bf16_f32 v32, v16, v17
  v_pk_fma_f32 v[8:9], v[18:19], v[18:19], v[8:9]
  v_cvt_pk_bf16_f32 v33, v18, v19
  v_pk_fma_f32 v[8:9], v[20:21], v[20:21], v[8:9]
  v_cvt_pk_bf16_f32 v34, v20, v21
  v_pk_fma_f32 v[8:9], v[22:23], v[22:23], v[8:9]
  v_cvt_pk_bf16_f32 v35, v22, v23
  v_pk_fma_f32 v[10:11], v[24:25], v[24:25], v[10:11]
  v_cvt_pk_bf16_f32 v36, v24, v25
  v_pk_fma_f32 v[10:11], v[26:27], v[26:27], v[10:11]
  v_cvt_pk_bf16_f32 v37, v26, v27
  v_pk_fma_f32 v[10:11], v[28:29], v[28:29], v[10:11]
  v_cvt_pk_bf16_f32 v38, v28, v29
  v_pk_fma_f32 v[10:11], v[30:31], v[30:31], v[10:11]
  v_cvt_pk_bf16_f32 v39, v30, v31
  ds_write_b128 v50, v[32:35] offset:256
  ds_write_b128 v50, v[36:39] offset:1344
  v_dot2_f32_bf16 v16, v82, s81, v54
  v_dot2_f32_bf16 v17, v82, s82, v54
  v_dot2_f32_bf16 v18, v86, s81, v54
  v_dot2_f32_bf16 v19, v86, s82, v54
  v_dot2_f32_bf16 v20, v90, s81, v54
  v_dot2_f32_bf16 v21, v90, s82, v54
  v_dot2_f32_bf16 v22, v94, s81, v54
  v_dot2_f32_bf16 v23, v94, s82, v54
  v_dot2_f32_bf16 v24, v83, s81, v55
  v_dot2_f32_bf16 v25, v83, s82, v55
  v_dot2_f32_bf16 v26, v87, s81, v55
  v_dot2_f32_bf16 v27, v87, s82, v55
  v_dot2_f32_bf16 v28, v91, s81, v55
  v_dot2_f32_bf16 v29, v91, s82, v55
  v_dot2_f32_bf16 v30, v95, s81, v55
  v_dot2_f32_bf16 v31, v95, s82, v55
  v_pk_fma_f32 v[12:13], v[16:17], v[16:17], v[12:13]
  v_cvt_pk_bf16_f32 v40, v16, v17
  v_pk_fma_f32 v[12:13], v[18:19], v[18:19], v[12:13]
  v_cvt_pk_bf16_f32 v41, v18, v19
  v_pk_fma_f32 v[12:13], v[20:21], v[20:21], v[12:13]
  v_cvt_pk_bf16_f32 v42, v20, v21
  v_pk_fma_f32 v[12:13], v[22:23], v[22:23], v[12:13]
  v_cvt_pk_bf16_f32 v43, v22, v23
  v_pk_fma_f32 v[14:15], v[24:25], v[24:25], v[14:15]
  v_cvt_pk_bf16_f32 v44, v24, v25
  v_pk_fma_f32 v[14:15], v[26:27], v[26:27], v[14:15]
  v_cvt_pk_bf16_f32 v45, v26, v27
  v_pk_fma_f32 v[14:15], v[28:29], v[28:29], v[14:15]
  v_cvt_pk_bf16_f32 v46, v28, v29
  v_pk_fma_f32 v[14:15], v[30:31], v[30:31], v[14:15]
  v_cvt_pk_bf16_f32 v47, v30, v31
  ds_write_b128 v50, v[40:43] offset:2432
  ds_write_b128 v50, v[44:47] offset:3520
  v_dot2_f32_bf16 v16, v96, s81, v52
  v_dot2_f32_bf16 v17, v96, s82, v52
  v_dot2_f32_bf16 v18, v100, s81, v52
  v_dot2_f32_bf16 v19, v100, s82, v52
  v_dot2_f32_bf16 v20, v104, s81, v52
  v_dot2_f32_bf16 v21, v104, s82, v52
  v_dot2_f32_bf16 v22, v108, s81, v52
  v_dot2_f32_bf16 v23, v108, s82, v52
  v_dot2_f32_bf16 v24, v97, s81, v53
  v_dot2_f32_bf16 v25, v97, s82, v53
  v_dot2_f32_bf16 v26, v101, s81, v53
  v_dot2_f32_bf16 v27, v101, s82, v53
  v_dot2_f32_bf16 v28, v105, s81, v53
  v_dot2_f32_bf16 v29, v105, s82, v53
  v_dot2_f32_bf16 v30, v109, s81, v53
  v_dot2_f32_bf16 v31, v109, s82, v53
  v_pk_fma_f32 v[8:9], v[16:17], v[16:17], v[8:9]
  v_cvt_pk_bf16_f32 v32, v16, v17
  v_pk_fma_f32 v[8:9], v[18:19], v[18:19], v[8:9]
  v_cvt_pk_bf16_f32 v33, v18, v19
  v_pk_fma_f32 v[8:9], v[20:21], v[20:21], v[8:9]
  v_cvt_pk_bf16_f32 v34, v20, v21
  v_pk_fma_f32 v[8:9], v[22:23], v[22:23], v[8:9]
  v_cvt_pk_bf16_f32 v35, v22, v23
  v_pk_fma_f32 v[10:11], v[24:25], v[24:25], v[10:11]
  v_cvt_pk_bf16_f32 v36, v24, v25
  v_pk_fma_f32 v[10:11], v[26:27], v[26:27], v[10:11]
  v_cvt_pk_bf16_f32 v37, v26, v27
  v_pk_fma_f32 v[10:11], v[28:29], v[28:29], v[10:11]
  v_cvt_pk_bf16_f32 v38, v28, v29
  v_pk_fma_f32 v[10:11], v[30:31], v[30:31], v[10:11]
  v_cvt_pk_bf16_f32 v39, v30, v31
  ds_write_b128 v50, v[32:35] offset:512
  ds_write_b128 v50, v[36:39] offset:1600
  v_dot2_f32_bf16 v16, v98, s81, v54
  v_dot2_f32_bf16 v17, v98, s82, v54
  v_dot2_f32_bf16 v18, v102, s81, v54
  v_dot2_f32_bf16 v19, v102, s82, v54
  v_dot2_f32_bf16 v20, v106, s81, v54
  v_dot2_f32_bf16 v21, v106, s82, v54
  v_dot2_f32_bf16 v22, v110, s81, v54
  v_dot2_f32_bf16 v23, v110, s82, v54
  v_dot2_f32_bf16 v24, v99, s81, v55
  v_dot2_f32_bf16 v25, v99, s82, v55
  v_dot2_f32_bf16 v26, v103, s81, v55
  v_dot2_f32_bf16 v27, v103, s82, v55
  v_dot2_f32_bf16 v28, v107, s81, v55
  v_dot2_f32_bf16 v29, v107, s82, v55
  v_dot2_f32_bf16 v30, v111, s81, v55
  v_dot2_f32_bf16 v31, v111, s82, v55
  v_pk_fma_f32 v[12:13], v[16:17], v[16:17], v[12:13]
  v_cvt_pk_bf16_f32 v40, v16, v17
  v_pk_fma_f32 v[12:13], v[18:19], v[18:19], v[12:13]
  v_cvt_pk_bf16_f32 v41, v18, v19
  v_pk_fma_f32 v[12:13], v[20:21], v[20:21], v[12:13]
  v_cvt_pk_bf16_f32 v42, v20, v21
  v_pk_fma_f32 v[12:13], v[22:23], v[22:23], v[12:13]
  v_cvt_pk_bf16_f32 v43, v22, v23
  v_pk_fma_f32 v[14:15], v[24:25], v[24:25], v[14:15]
  v_cvt_pk_bf16_f32 v44, v24, v25
  v_pk_fma_f32 v[14:15], v[26:27], v[26:27], v[14:15]
  v_cvt_pk_bf16_f32 v45, v26, v27
  v_pk_fma_f32 v[14:15], v[28:29], v[28:29], v[14:15]
  v_cvt_pk_bf16_f32 v46, v28, v29
  v_pk_fma_f32 v[14:15], v[30:31], v[30:31], v[14:15]
  v_cvt_pk_bf16_f32 v47, v30, v31
  ds_write_b128 v50, v[40:43] offset:2688
  ds_write_b128 v50, v[44:47] offset:3776
  v_dot2_f32_bf16 v16, v112, s81, v52
  v_dot2_f32_bf16 v17, v112, s82, v52
  v_dot2_f32_bf16 v18, v116, s81, v52
  v_dot2_f32_bf16 v19, v116, s82, v52
  v_dot2_f32_bf16 v20, v120, s81, v52
  v_dot2_f32_bf16 v21, v120, s82, v52
  v_dot2_f32_bf16 v22, v124, s81, v52
  v_dot2_f32_bf16 v23, v124, s82, v52
  v_dot2_f32_bf16 v24, v113, s81, v53
  v_dot2_f32_bf16 v25, v113, s82, v53
  v_dot2_f32_bf16 v26, v117, s81, v53
  v_dot2_f32_bf16 v27, v117, s82, v53
  v_dot2_f32_bf16 v28, v121, s81, v53
  v_dot2_f32_bf16 v29, v121, s82, v53
  v_dot2_f32_bf16 v30, v125, s81, v53
  v_dot2_f32_bf16 v31, v125, s82, v53
  v_pk_fma_f32 v[8:9], v[16:17], v[16:17], v[8:9]
  v_cvt_pk_bf16_f32 v32, v16, v17
  v_pk_fma_f32 v[8:9], v[18:19], v[18:19], v[8:9]
  v_cvt_pk_bf16_f32 v33, v18, v19
  v_pk_fma_f32 v[8:9], v[20:21], v[20:21], v[8:9]
  v_cvt_pk_bf16_f32 v34, v20, v21
  v_pk_fma_f32 v[8:9], v[22:23], v[22:23], v[8:9]
  v_cvt_pk_bf16_f32 v35, v22, v23
  v_pk_fma_f32 v[10:11], v[24:25], v[24:25], v[10:11]
  v_cvt_pk_bf16_f32 v36, v24, v25
  v_pk_fma_f32 v[10:11], v[26:27], v[26:27], v[10:11]
  v_cvt_pk_bf16_f32 v37, v26, v27
  v_pk_fma_f32 v[10:11], v[28:29], v[28:29], v[10:11]
  v_cvt_pk_bf16_f32 v38, v28, v29
  v_pk_fma_f32 v[10:11], v[30:31], v[30:31], v[10:11]
  v_cvt_pk_bf16_f32 v39, v30, v31
  ds_write_b128 v50, v[32:35] offset:768
  ds_write_b128 v50, v[36:39] offset:1856
  v_dot2_f32_bf16 v16, v114, s81, v54
  v_dot2_f32_bf16 v17, v114, s82, v54
  v_dot2_f32_bf16 v18, v118, s81, v54
  v_dot2_f32_bf16 v19, v118, s82, v54
  v_dot2_f32_bf16 v20, v122, s81, v54
  v_dot2_f32_bf16 v21, v122, s82, v54
  v_dot2_f32_bf16 v22, v126, s81, v54
  v_dot2_f32_bf16 v23, v126, s82, v54
  v_dot2_f32_bf16 v24, v115, s81, v55
  v_dot2_f32_bf16 v25, v115, s82, v55
  v_dot2_f32_bf16 v26, v119, s81, v55
  v_dot2_f32_bf16 v27, v119, s82, v55
  v_dot2_f32_bf16 v28, v123, s81, v55
  v_dot2_f32_bf16 v29, v123, s82, v55
  v_dot2_f32_bf16 v30, v127, s81, v55
  v_dot2_f32_bf16 v31, v127, s82, v55
  v_pk_fma_f32 v[12:13], v[16:17], v[16:17], v[12:13]
  v_cvt_pk_bf16_f32 v40, v16, v17
  v_pk_fma_f32 v[12:13], v[18:19], v[18:19], v[12:13]
  v_cvt_pk_bf16_f32 v41, v18, v19
  v_pk_fma_f32 v[12:13], v[20:21], v[20:21], v[12:13]
  v_cvt_pk_bf16_f32 v42, v20, v21
  v_pk_fma_f32 v[12:13], v[22:23], v[22:23], v[12:13]
  v_cvt_pk_bf16_f32 v43, v22, v23
  v_pk_fma_f32 v[14:15], v[24:25], v[24:25], v[14:15]
  v_cvt_pk_bf16_f32 v44, v24, v25
  v_pk_fma_f32 v[14:15], v[26:27], v[26:27], v[14:15]
  v_cvt_pk_bf16_f32 v45, v26, v27
  v_pk_fma_f32 v[14:15], v[28:29], v[28:29], v[14:15]
  v_cvt_pk_bf16_f32 v46, v28, v29
  v_pk_fma_f32 v[14:15], v[30:31], v[30:31], v[14:15]
  v_cvt_pk_bf16_f32 v47, v30, v31
  ds_write_b128 v50, v[40:43] offset:2944
  ds_write_b128 v50, v[44:47] offset:4032
  v_add_f32 v60, v8, v9
  v_add_f32 v61, v10, v11
  v_add_f32 v62, v12, v13
  v_add_f32 v63, v14, v15
  v_mov_b32 v12, v60
  v_mov_b32 v13, v61
  v_mov_b32 v14, v62
  v_mov_b32 v15, v63
  v_permlane32_swap_b32 v60, v12
  v_permlane32_swap_b32 v61, v13
  v_permlane32_swap_b32 v62, v14
  v_permlane32_swap_b32 v63, v15
  v_add_f32 v60, v60, v12
  v_add_f32 v61, v61, v13
  v_add_f32 v62, v62, v14
  v_add_f32 v63, v63, v15
  v_add_u32 v50, 144384, v49
  ds_write_b128 v50, v[60:63]
  s_waitcnt lgkmcnt(0)
  s_barrier
  v_add_u32 v23, 144384, v48
  v_mov_b32 v24, v56
  v_mov_b32 v25, v57
  v_mov_b32 v26, v58
  v_mov_b32 v27, v59
  v_and_b32 v3, 15, v1
  v_lshrrev_b32 v4, 4, v1
  v_and_b32 v5, 3, v3
  v_mul_u32_u24 v5, 1088, v5
  v_lshrrev_b32 v6, 2, v3
  v_mul_u32_u24 v6, 4384, v6
  v_add_u32 v5, v5, v6
  v_lshl_add_u32 v28, v4, 4, v5
  v_add_u32 v29, 70144, v28
  v_mul_u32_u24 v30, 44032, v4
  v_lshl_add_u32 v30, v3, 4, v30
  v_lshlrev_b32 v31, 2, v3
  v_add_u32 v31, 148480, v31
  v_lshlrev_b32 v7, 4, v1
  s_waitcnt lgkmcnt(0)
  s_cmp_lt_u32 s3, s9
  s_cbranch_scc1 G1_TWO
  s_cmp_lt_u32 s3, 3
  s_cbranch_scc1 G1_16
  ds_read_b128 v[32:35], v28 offset:0
  ds_read_b128 v[36:39], v28 offset:17536
  ds_read_b128 v[40:43], v28 offset:35072
  ds_read_b128 v[44:47], v28 offset:52608
  ds_read_b128 v[48:51], v29 offset:0
  ds_read_b128 v[52:55], v29 offset:17536
  ds_read_b128 v[56:59], v29 offset:35072
  ds_read_b128 v[60:63], v29 offset:52608
  s_waitcnt lgkmcnt(4)
  v_mfma_f32_16x16x32_bf16 v[64:67], a[0:3], v[32:35], 0
  v_mfma_f32_16x16x32_bf16 v[68:71], a[0:3], v[36:39], 0
  v_mfma_f32_16x16x32_bf16 v[72:75], a[0:3], v[40:43], 0
  v_mfma_f32_16x16x32_bf16 v[76:79], a[0:3], v[44:47], 0
  ds_read_b128 v[32:35], v28 offset:64
  ds_read_b128 v[36:39], v28 offset:17600
  ds_read_b128 v[40:43], v28 offset:35136
  ds_read_b128 v[44:47], v28 offset:52672
  s_waitcnt lgkmcnt(4)
  v_mfma_f32_16x16x32_bf16 v[80:83], a[0:3], v[48:51], 0
  v_mfma_f32_16x16x32_bf16 v[84:87], a[0:3], v[52:55], 0
  v_mfma_f32_16x16x32_bf16 v[88:91], a[0:3], v[56:59], 0
  v_mfma_f32_16x16x32_bf16 v[92:95], a[0:3], v[60:63], 0
  ds_read_b128 v[48:51], v29 offset:64
  ds_read_b128 v[52:55], v29 offset:17600
  ds_read_b128 v[56:59], v29 offset:35136
  ds_read_b128 v[60:63], v29 offset:52672
  s_waitcnt lgkmcnt(4)
  v_mfma_f32_16x16x32_bf16 v[64:67], a[4:7], v[32:35], v[64:67]
  v_mfma_f32_16x16x32_bf16 v[68:71], a[4:7], v[36:39], v[68:71]
  v_mfma_f32_16x16x32_bf16 v[72:75], a[4:7], v[40:43], v[72:75]
  v_mfma_f32_16x16x32_bf16 v[76:79], a[4:7], v[44:47], v[76:79]
  ds_read_b128 v[32:35], v28 offset:128
  ds_read_b128 v[36:39], v28 offset:17664
  ds_read_b128 v[40:43], v28 offset:35200
  ds_read_b128 v[44:47], v28 offset:52736
  s_waitcnt lgkmcnt(4)
  v_mfma_f32_16x16x32_bf16 v[80:83], a[4:7], v[48:51], v[80:83]
  v_mfma_f32_16x16x32_bf16 v[84:87], a[4:7], v[52:55], v[84:87]
  v_mfma_f32_16x16x32_bf16 v[88:91], a[4:7], v[56:59], v[88:91]
  v_mfma_f32_16x16x32_bf16 v[92:95], a[4:7], v[60:63], v[92:95]
  ds_read_b128 v[8:11], v23
  ds_read_b128 v[12:15], v23 offset:512
  ds_read_b128 v[16:19], v23 offset:1024
  s_waitcnt lgkmcnt(0)
  v_add_f32 v12, v12, v16
  v_add_f32 v13, v13, v17
  v_add_f32 v14, v14, v18
  v_add_f32 v15, v15, v19
  v_add_f32 v8, v8, v12
  v_add_f32 v9, v9, v13
  v_add_f32 v10, v10, v14
  v_add_f32 v11, v11, v15
  ds_read_b128 v[12:15], v23 offset:1536
  ds_read_b128 v[16:19], v23 offset:2048
  s_waitcnt lgkmcnt(0)
  v_add_f32 v12, v12, v16
  v_add_f32 v13, v13, v17
  v_add_f32 v14, v14, v18
  v_add_f32 v15, v15, v19
  v_add_f32 v8, v8, v12
  v_add_f32 v9, v9, v13
  v_add_f32 v10, v10, v14
  v_add_f32 v11, v11, v15
  ds_read_b128 v[12:15], v23 offset:2560
  ds_read_b128 v[16:19], v23 offset:3072
  s_waitcnt lgkmcnt(0)
  v_add_f32 v12, v12, v16
  v_add_f32 v13, v13, v17
  v_add_f32 v14, v14, v18
  v_add_f32 v15, v15, v19
  v_add_f32 v8, v8, v12
  v_add_f32 v9, v9, v13
  v_add_f32 v10, v10, v14
  v_add_f32 v11, v11, v15
  ds_read_b128 v[12:15], v23 offset:3584
  v_mov_b32 v16, 0
  v_mov_b32 v17, 0
  v_mov_b32 v18, 0
  v_mov_b32 v19, 0
  s_waitcnt lgkmcnt(0)
  v_add_f32 v8, v8, v12
  v_add_f32 v9, v9, v13
  v_add_f32 v10, v10, v14
  v_add_f32 v11, v11, v15
  v_mul_f32 v24, v24, v24
  v_mul_f32 v25, v25, v25
  v_mul_f32 v26, v26, v26
  v_mul_f32 v27, v27, v27
  s_mov_b32 s15, 0x3b000000
  v_fma_f32 v8, v8, s15, -v24
  v_fma_f32 v9, v9, s15, -v25
  v_fma_f32 v10, v10, s15, -v26
  v_fma_f32 v11, v11, s15, -v27
  v_max_f32 v8, 0, v8
  v_max_f32 v9, 0, v9
  v_max_f32 v10, 0, v10
  v_max_f32 v11, 0, v11
  v_cvt_pk_bf16_f32 v8, v8, v8
  v_cvt_pk_bf16_f32 v9, v9, v9
  v_cvt_pk_bf16_f32 v10, v10, v10
  v_cvt_pk_bf16_f32 v11, v11, v11
  v_and_b32 v8, 0xffff0000, v8
  v_and_b32 v9, 0xffff0000, v9
  v_and_b32 v10, 0xffff0000, v10
  v_and_b32 v11, 0xffff0000, v11
  v_add_f32 v8, 0x3727c5ac, v8
  v_add_f32 v9, 0x3727c5ac, v9
  v_add_f32 v10, 0x3727c5ac, v10
  v_add_f32 v11, 0x3727c5ac, v11
  v_cvt_pk_bf16_f32 v8, v8, v8
  v_cvt_pk_bf16_f32 v9, v9, v9
  v_cvt_pk_bf16_f32 v10, v10, v10
  v_cvt_pk_bf16_f32 v11, v11, v11
  v_and_b32 v8, 0xffff0000, v8
  v_and_b32 v9, 0xffff0000, v9
  v_and_b32 v10, 0xffff0000, v10
  v_and_b32 v11, 0xffff0000, v11
  v_sqrt_f32 v8, v8
  v_sqrt_f32 v9, v9
  v_sqrt_f32 v10, v10
  v_sqrt_f32 v11, v11
  v_cvt_pk_bf16_f32 v8, v8, v8
  v_cvt_pk_bf16_f32 v9, v9, v9
  v_cvt_pk_bf16_f32 v10, v10, v10
  v_cvt_pk_bf16_f32 v11, v11, v11
  v_and_b32 v8, 0xffff0000, v8
  v_and_b32 v9, 0xffff0000, v9
  v_and_b32 v10, 0xffff0000, v10
  v_and_b32 v11, 0xffff0000, v11
  v_rcp_f32 v8, v8
  v_rcp_f32 v9, v9
  v_rcp_f32 v10, v10
  v_rcp_f32 v11, v11
  v_add_u32 v22, 4096, v23
  ds_write_b128 v22, v[8:11]
  s_waitcnt lgkmcnt(0)
  ds_read_b32 v8, v31 offset:0
  ds_read_b32 v10, v31 offset:64
  ds_read_b32 v12, v31 offset:128
  ds_read_b32 v14, v31 offset:192
  ds_read_b32 v16, v31 offset:256
  ds_read_b32 v18, v31 offset:320
  ds_read_b32 v20, v31 offset:384
  ds_read_b32 v22, v31 offset:448
  s_waitcnt lgkmcnt(0)
  ds_read_b128 v[48:51], v29 offset:128
  ds_read_b128 v[52:55], v29 offset:17664
  ds_read_b128 v[56:59], v29 offset:35200
  ds_read_b128 v[60:63], v29 offset:52736
  s_waitcnt lgkmcnt(4)
  v_mfma_f32_16x16x32_bf16 v[64:67], a[8:11], v[32:35], v[64:67]
  v_mfma_f32_16x16x32_bf16 v[68:71], a[8:11], v[36:39], v[68:71]
  v_mfma_f32_16x16x32_bf16 v[72:75], a[8:11], v[40:43], v[72:75]
  v_mfma_f32_16x16x32_bf16 v[76:79], a[8:11], v[44:47], v[76:79]
  ds_read_b128 v[32:35], v28 offset:192
  ds_read_b128 v[36:39], v28 offset:17728
  ds_read_b128 v[40:43], v28 offset:35264
  ds_read_b128 v[44:47], v28 offset:52800
  s_waitcnt lgkmcnt(4)
  v_mfma_f32_16x16x32_bf16 v[80:83], a[8:11], v[48:51], v[80:83]
  v_mfma_f32_16x16x32_bf16 v[84:87], a[8:11], v[52:55], v[84:87]
  v_mfma_f32_16x16x32_bf16 v[88:91], a[8:11], v[56:59], v[88:91]
  v_mfma_f32_16x16x32_bf16 v[92:95], a[8:11], v[60:63], v[92:95]
  ds_read_b128 v[48:51], v29 offset:192
  ds_read_b128 v[52:55], v29 offset:17728
  ds_read_b128 v[56:59], v29 offset:35264
  ds_read_b128 v[60:63], v29 offset:52800
  s_waitcnt lgkmcnt(4)
  v_mfma_f32_16x16x32_bf16 v[64:67], a[12:15], v[32:35], v[64:67]
  v_mfma_f32_16x16x32_bf16 v[68:71], a[12:15], v[36:39], v[68:71]
  v_mfma_f32_16x16x32_bf16 v[72:75], a[12:15], v[40:43], v[72:75]
  v_mfma_f32_16x16x32_bf16 v[76:79], a[12:15], v[44:47], v[76:79]
  ds_read_b128 v[32:35], v28 offset:256
  ds_read_b128 v[36:39], v28 offset:17792
  ds_read_b128 v[40:43], v28 offset:35328
  ds_read_b128 v[44:47], v28 offset:52864
  s_waitcnt lgkmcnt(4)
  v_mfma_f32_16x16x32_bf16 v[80:83], a[12:15], v[48:51], v[80:83]
  v_mfma_f32_16x16x32_bf16 v[84:87], a[12:15], v[52:55], v[84:87]
  v_mfma_f32_16x16x32_bf16 v[88:91], a[12:15], v[56:59], v[88:91]
  v_mfma_f32_16x16x32_bf16 v[92:95], a[12:15], v[60:63], v[92:95]
  buffer_load_dwordx4 a[0:3], v7, s[48:51], s60 offen offset:0 sc1
  buffer_load_dwordx4 a[4:7], v7, s[48:51], s61 offen offset:0 sc1
  buffer_load_dwordx4 a[8:11], v7, s[48:51], s62 offen offset:0 sc1
  buffer_load_dwordx4 a[12:15], v7, s[48:51], s63 offen offset:0 sc1
  s_add_u32 s60, s60, 8192
  s_add_u32 s61, s61, 8192
  s_add_u32 s62, s62, 8192
  s_add_u32 s63, s63, 8192
  buffer_load_dwordx4 a[64:67], v7, s[48:51], s60 offen offset:0 sc1
  buffer_load_dwordx4 a[68:71], v7, s[48:51], s61 offen offset:0 sc1
  buffer_load_dwordx4 a[72:75], v7, s[48:51], s62 offen offset:0 sc1
  buffer_load_dwordx4 a[76:79], v7, s[48:51], s63 offen offset:0 sc1
  s_add_u32 s60, s60, 8192
  s_add_u32 s61, s61, 8192
  s_add_u32 s62, s62, 8192
  s_add_u32 s63, s63, 8192
  ds_read_b128 v[48:51], v29 offset:256
  ds_read_b128 v[52:55], v29 offset:17792
  ds_read_b128 v[56:59], v29 offset:35328
  ds_read_b128 v[60:63], v29 offset:52864
  s_waitcnt lgkmcnt(4)
  v_mfma_f32_16x16x32_bf16 v[64:67], a[16:19], v[32:35], v[64:67]
  v_mfma_f32_16x16x32_bf16 v[68:71], a[16:19], v[36:39], v[68:71]
  v_mfma_f32_16x16x32_bf16 v[72:75], a[16:19], v[40:43], v[72:75]
  v_mfma_f32_16x16x32_bf16 v[76:79], a[16:19], v[44:47], v[76:79]
  ds_read_b128 v[32:35], v28 offset:320
  ds_read_b128 v[36:39], v28 offset:17856
  ds_read_b128 v[40:43], v28 offset:35392
  ds_read_b128 v[44:47], v28 offset:52928
  s_waitcnt lgkmcnt(4)
  v_mfma_f32_16x16x32_bf16 v[80:83], a[16:19], v[48:51], v[80:83]
  v_mfma_f32_16x16x32_bf16 v[84:87], a[16:19], v[52:55], v[84:87]
  v_mfma_f32_16x16x32_bf16 v[88:91], a[16:19], v[56:59], v[88:91]
  v_mfma_f32_16x16x32_bf16 v[92:95], a[16:19], v[60:63], v[92:95]
  ds_read_b128 v[48:51], v29 offset:320
  ds_read_b128 v[52:55], v29 offset:17856
  ds_read_b128 v[56:59], v29 offset:35392
  ds_read_b128 v[60:63], v29 offset:52928
  s_waitcnt lgkmcnt(4)
  v_mfma_f32_16x16x32_bf16 v[64:67], a[20:23], v[32:35], v[64:67]
  v_mfma_f32_16x16x32_bf16 v[68:71], a[20:23], v[36:39], v[68:71]
  v_mfma_f32_16x16x32_bf16 v[72:75], a[20:23], v[40:43], v[72:75]
  v_mfma_f32_16x16x32_bf16 v[76:79], a[20:23], v[44:47], v[76:79]
  ds_read_b128 v[32:35], v28 offset:384
  ds_read_b128 v[36:39], v28 offset:17920
  ds_read_b128 v[40:43], v28 offset:35456
  ds_read_b128 v[44:47], v28 offset:52992
  s_waitcnt lgkmcnt(4)
  v_mfma_f32_16x16x32_bf16 v[80:83], a[20:23], v[48:51], v[80:83]
  v_mfma_f32_16x16x32_bf16 v[84:87], a[20:23], v[52:55], v[84:87]
  v_mfma_f32_16x16x32_bf16 v[88:91], a[20:23], v[56:59], v[88:91]
  v_mfma_f32_16x16x32_bf16 v[92:95], a[20:23], v[60:63], v[92:95]
  ds_read_b128 v[48:51], v29 offset:384
  ds_read_b128 v[52:55], v29 offset:17920
  ds_read_b128 v[56:59], v29 offset:35456
  ds_read_b128 v[60:63], v29 offset:52992
  s_waitcnt lgkmcnt(4)
  v_mfma_f32_16x16x32_bf16 v[64:67], a[24:27], v[32:35], v[64:67]
  v_mfma_f32_16x16x32_bf16 v[68:71], a[24:27], v[36:39], v[68:71]
  v_mfma_f32_16x16x32_bf16 v[72:75], a[24:27], v[40:43], v[72:75]
  v_mfma_f32_16x16x32_bf16 v[76:79], a[24:27], v[44:47], v[76:79]
  ds_read_b128 v[32:35], v28 offset:448
  ds_read_b128 v[36:39], v28 offset:17984
  ds_read_b128 v[40:43], v28 offset:35520
  ds_read_b128 v[44:47], v28 offset:53056
  s_waitcnt lgkmcnt(4)
  v_mfma_f32_16x16x32_bf16 v[80:83], a[24:27], v[48:51], v[80:83]
  v_mfma_f32_16x16x32_bf16 v[84:87], a[24:27], v[52:55], v[84:87]
  v_mfma_f32_16x16x32_bf16 v[88:91], a[24:27], v[56:59], v[88:91]
  v_mfma_f32_16x16x32_bf16 v[92:95], a[24:27], v[60:63], v[92:95]
  ds_read_b128 v[48:51], v29 offset:448
  ds_read_b128 v[52:55], v29 offset:17984
  ds_read_b128 v[56:59], v29 offset:35520
  ds_read_b128 v[60:63], v29 offset:53056
  s_waitcnt lgkmcnt(4)
  v_mfma_f32_16x16x32_bf16 v[64:67], a[28:31], v[32:35], v[64:67]
  v_mfma_f32_16x16x32_bf16 v[68:71], a[28:31], v[36:39], v[68:71]
  v_mfma_f32_16x16x32_bf16 v[72:75], a[28:31], v[40:43], v[72:75]
  v_mfma_f32_16x16x32_bf16 v[76:79], a[28:31], v[44:47], v[76:79]
  ds_read_b128 v[32:35], v28 offset:512
  ds_read_b128 v[36:39], v28 offset:18048
  ds_read_b128 v[40:43], v28 offset:35584
  ds_read_b128 v[44:47], v28 offset:53120
  s_waitcnt lgkmcnt(4)
  v_mfma_f32_16x16x32_bf16 v[80:83], a[28:31], v[48:51], v[80:83]
  v_mfma_f32_16x16x32_bf16 v[84:87], a[28:31], v[52:55], v[84:87]
  v_mfma_f32_16x16x32_bf16 v[88:91], a[28:31], v[56:59], v[88:91]
  v_mfma_f32_16x16x32_bf16 v[92:95], a[28:31], v[60:63], v[92:95]
  buffer_load_dwordx4 a[16:19], v7, s[48:51], s60 offen offset:0 sc1
  buffer_load_dwordx4 a[20:23], v7, s[48:51], s61 offen offset:0 sc1
  buffer_load_dwordx4 a[24:27], v7, s[48:51], s62 offen offset:0 sc1
  buffer_load_dwordx4 a[28:31], v7, s[48:51], s63 offen offset:0 sc1
  s_add_u32 s60, s60, 8192
  s_add_u32 s61, s61, 8192
  s_add_u32 s62, s62, 8192
  s_add_u32 s63, s63, 8192
  buffer_load_dwordx4 a[80:83], v7, s[48:51], s60 offen offset:0 sc1
  buffer_load_dwordx4 a[84:87], v7, s[48:51], s61 offen offset:0 sc1
  buffer_load_dwordx4 a[88:91], v7, s[48:51], s62 offen offset:0 sc1
  buffer_load_dwordx4 a[92:95], v7, s[48:51], s63 offen offset:0 sc1
  s_add_u32 s60, s60, 8192
  s_add_u32 s61, s61, 8192
  s_add_u32 s62, s62, 8192
  s_add_u32 s63, s63, 8192
  ds_read_b128 v[48:51], v29 offset:512
  ds_read_b128 v[52:55], v29 offset:18048
  ds_read_b128 v[56:59], v29 offset:35584
  ds_read_b128 v[60:63], v29 offset:53120
  s_waitcnt lgkmcnt(4)
  v_mfma_f32_16x16x32_bf16 v[64:67], a[32:35], v[32:35], v[64:67]
  v_mfma_f32_16x16x32_bf16 v[68:71], a[32:35], v[36:39], v[68:71]
  v_mfma_f32_16x16x32_bf16 v[72:75], a[32:35], v[40:43], v[72:75]
  v_mfma_f32_16x16x32_bf16 v[76:79], a[32:35], v[44:47], v[76:79]
  ds_read_b128 v[32:35], v28 offset:576
  ds_read_b128 v[36:39], v28 offset:18112
  ds_read_b128 v[40:43], v28 offset:35648
  ds_read_b128 v[44:47], v28 offset:53184
  s_waitcnt lgkmcnt(4)
  v_mfma_f32_16x16x32_bf16 v[80:83], a[32:35], v[48:51], v[80:83]
  v_mfma_f32_16x16x32_bf16 v[84:87], a[32:35], v[52:55], v[84:87]
  v_mfma_f32_16x16x32_bf16 v[88:91], a[32:35], v[56:59], v[88:91]
  v_mfma_f32_16x16x32_bf16 v[92:95], a[32:35], v[60:63], v[92:95]
  ds_read_b128 v[48:51], v29 offset:576
  ds_read_b128 v[52:55], v29 offset:18112
  ds_read_b128 v[56:59], v29 offset:35648
  ds_read_b128 v[60:63], v29 offset:53184
  s_waitcnt lgkmcnt(4)
  v_mfma_f32_16x16x32_bf16 v[64:67], a[36:39], v[32:35], v[64:67]
  v_mfma_f32_16x16x32_bf16 v[68:71], a[36:39], v[36:39], v[68:71]
  v_mfma_f32_16x16x32_bf16 v[72:75], a[36:39], v[40:43], v[72:75]
  v_mfma_f32_16x16x32_bf16 v[76:79], a[36:39], v[44:47], v[76:79]
  ds_read_b128 v[32:35], v28 offset:640
  ds_read_b128 v[36:39], v28 offset:18176
  ds_read_b128 v[40:43], v28 offset:35712
  ds_read_b128 v[44:47], v28 offset:53248
  s_waitcnt lgkmcnt(4)
  v_mfma_f32_16x16x32_bf16 v[80:83], a[36:39], v[48:51], v[80:83]
  v_mfma_f32_16x16x32_bf16 v[84:87], a[36:39], v[52:55], v[84:87]
  v_mfma_f32_16x16x32_bf16 v[88:91], a[36:39], v[56:59], v[88:91]
  v_mfma_f32_16x16x32_bf16 v[92:95], a[36:39], v[60:63], v[92:95]
  ds_read_b128 v[48:51], v29 offset:640
  ds_read_b128 v[52:55], v29 offset:18176
  ds_read_b128 v[56:59], v29 offset:35712
  ds_read_b128 v[60:63], v29 offset:53248
  s_waitcnt lgkmcnt(4)
  v_mfma_f32_16x16x32_bf16 v[64:67], a[40:43], v[32:35], v[64:67]
  v_mfma_f32_16x16x32_bf16 v[68:71], a[40:43], v[36:39], v[68:71]
  v_mfma_f32_16x16x32_bf16 v[72:75], a[40:43], v[40:43], v[72:75]
  v_mfma_f32_16x16x32_bf16 v[76:79], a[40:43], v[44:47], v[76:79]
  ds_read_b128 v[32:35], v28 offset:704
  ds_read_b128 v[36:39], v28 offset:18240
  ds_read_b128 v[40:43], v28 offset:35776
  ds_read_b128 v[44:47], v28 offset:53312
  s_waitcnt lgkmcnt(4)
  v_mfma_f32_16x16x32_bf16 v[80:83], a[40:43], v[48:51], v[80:83]
  v_mfma_f32_16x16x32_bf16 v[84:87], a[40:43], v[52:55], v[84:87]
  v_mfma_f32_16x16x32_bf16 v[88:91], a[40:43], v[56:59], v[88:91]
  v_mfma_f32_16x16x32_bf16 v[92:95], a[40:43], v[60:63], v[92:95]
  ds_read_b128 v[48:51], v29 offset:704
  ds_read_b128 v[52:55], v29 offset:18240
  ds_read_b128 v[56:59], v29 offset:35776
  ds_read_b128 v[60:63], v29 offset:53312
  s_waitcnt lgkmcnt(4)
  v_mfma_f32_16x16x32_bf16 v[64:67], a[44:47], v[32:35], v[64:67]
  v_mfma_f32_16x16x32_bf16 v[68:71], a[44:47], v[36:39], v[68:71]
  v_mfma_f32_16x16x32_bf16 v[72:75], a[44:47], v[40:43], v[72:75]
  v_mfma_f32_16x16x32_bf16 v[76:79], a[44:47], v[44:47], v[76:79]
  ds_read_b128 v[32:35], v28 offset:768
  ds_read_b128 v[36:39], v28 offset:18304
  ds_read_b128 v[40:43], v28 offset:35840
  ds_read_b128 v[44:47], v28 offset:53376
  s_waitcnt lgkmcnt(4)
  v_mfma_f32_16x16x32_bf16 v[80:83], a[44:47], v[48:51], v[80:83]
  v_mfma_f32_16x16x32_bf16 v[84:87], a[44:47], v[52:55], v[84:87]
  v_mfma_f32_16x16x32_bf16 v[88:91], a[44:47], v[56:59], v[88:91]
  v_mfma_f32_16x16x32_bf16 v[92:95], a[44:47], v[60:63], v[92:95]
  buffer_load_dwordx4 a[32:35], v7, s[48:51], s60 offen offset:0 sc1
  buffer_load_dwordx4 a[36:39], v7, s[48:51], s61 offen offset:0 sc1
  buffer_load_dwordx4 a[40:43], v7, s[48:51], s62 offen offset:0 sc1
  buffer_load_dwordx4 a[44:47], v7, s[48:51], s63 offen offset:0 sc1
  s_add_u32 s60, s60, 8192
  s_add_u32 s61, s61, 8192
  s_add_u32 s62, s62, 8192
  s_add_u32 s63, s63, 8192
  ds_read_b128 v[48:51], v29 offset:768
  ds_read_b128 v[52:55], v29 offset:18304
  ds_read_b128 v[56:59], v29 offset:35840
  ds_read_b128 v[60:63], v29 offset:53376
  s_waitcnt lgkmcnt(4)
  v_mfma_f32_16x16x32_bf16 v[64:67], a[48:51], v[32:35], v[64:67]
  v_mfma_f32_16x16x32_bf16 v[68:71], a[48:51], v[36:39], v[68:71]
  v_mfma_f32_16x16x32_bf16 v[72:75], a[48:51], v[40:43], v[72:75]
  v_mfma_f32_16x16x32_bf16 v[76:79], a[48:51], v[44:47], v[76:79]
  ds_read_b128 v[32:35], v28 offset:832
  ds_read_b128 v[36:39], v28 offset:18368
  ds_read_b128 v[40:43], v28 offset:35904
  ds_read_b128 v[44:47], v28 offset:53440
  s_waitcnt lgkmcnt(4)
  v_mfma_f32_16x16x32_bf16 v[80:83], a[48:51], v[48:51], v[80:83]
  v_mfma_f32_16x16x32_bf16 v[84:87], a[48:51], v[52:55], v[84:87]
  v_mfma_f32_16x16x32_bf16 v[88:91], a[48:51], v[56:59], v[88:91]
  v_mfma_f32_16x16x32_bf16 v[92:95], a[48:51], v[60:63], v[92:95]
  ds_read_b128 v[48:51], v29 offset:832
  ds_read_b128 v[52:55], v29 offset:18368
  ds_read_b128 v[56:59], v29 offset:35904
  ds_read_b128 v[60:63], v29 offset:53440
  s_waitcnt lgkmcnt(4)
  v_mfma_f32_16x16x32_bf16 v[64:67], a[52:55], v[32:35], v[64:67]
  v_mfma_f32_16x16x32_bf16 v[68:71], a[52:55], v[36:39], v[68:71]
  v_mfma_f32_16x16x32_bf16 v[72:75], a[52:55], v[40:43], v[72:75]
  v_mfma_f32_16x16x32_bf16 v[76:79], a[52:55], v[44:47], v[76:79]
  ds_read_b128 v[32:35], v28 offset:896
  ds_read_b128 v[36:39], v28 offset:18432
  ds_read_b128 v[40:43], v28 offset:35968
  ds_read_b128 v[44:47], v28 offset:53504
  s_waitcnt lgkmcnt(4)
  v_mfma_f32_16x16x32_bf16 v[80:83], a[52:55], v[48:51], v[80:83]
  v_mfma_f32_16x16x32_bf16 v[84:87], a[52:55], v[52:55], v[84:87]
  v_mfma_f32_16x16x32_bf16 v[88:91], a[52:55], v[56:59], v[88:91]
  v_mfma_f32_16x16x32_bf16 v[92:95], a[52:55], v[60:63], v[92:95]
  ds_read_b128 v[48:51], v29 offset:896
  ds_read_b128 v[52:55], v29 offset:18432
  ds_read_b128 v[56:59], v29 offset:35968
  ds_read_b128 v[60:63], v29 offset:53504
  s_waitcnt lgkmcnt(4)
  v_mfma_f32_16x16x32_bf16 v[64:67], a[56:59], v[32:35], v[64:67]
  v_mfma_f32_16x16x32_bf16 v[68:71], a[56:59], v[36:39], v[68:71]
  v_mfma_f32_16x16x32_bf16 v[72:75], a[56:59], v[40:43], v[72:75]
  v_mfma_f32_16x16x32_bf16 v[76:79], a[56:59], v[44:47], v[76:79]
  ds_read_b128 v[32:35], v28 offset:960
  ds_read_b128 v[36:39], v28 offset:18496
  ds_read_b128 v[40:43], v28 offset:36032
  ds_read_b128 v[44:47], v28 offset:53568
  s_waitcnt lgkmcnt(4)
  v_mfma_f32_16x16x32_bf16 v[80:83], a[56:59], v[48:51], v[80:83]
  v_mfma_f32_16x16x32_bf16 v[84:87], a[56:59], v[52:55], v[84:87]
  v_mfma_f32_16x16x32_bf16 v[88:91], a[56:59], v[56:59], v[88:91]
  v_mfma_f32_16x16x32_bf16 v[92:95], a[56:59], v[60:63], v[92:95]
  ds_read_b128 v[48:51], v29 offset:960
  ds_read_b128 v[52:55], v29 offset:18496
  ds_read_b128 v[56:59], v29 offset:36032
  ds_read_b128 v[60:63], v29 offset:53568
  s_waitcnt lgkmcnt(4)
  v_mfma_f32_16x16x32_bf16 v[64:67], a[60:63], v[32:35], v[64:67]
  v_mfma_f32_16x16x32_bf16 v[68:71], a[60:63], v[36:39], v[68:71]
  v_mfma_f32_16x16x32_bf16 v[72:75], a[60:63], v[40:43], v[72:75]
  v_mfma_f32_16x16x32_bf16 v[76:79], a[60:63], v[44:47], v[76:79]
  s_waitcnt lgkmcnt(0)
  v_mfma_f32_16x16x32_bf16 v[80:83], a[60:63], v[48:51], v[80:83]
  v_mfma_f32_16x16x32_bf16 v[84:87], a[60:63], v[52:55], v[84:87]
  v_mfma_f32_16x16x32_bf16 v[88:91], a[60:63], v[56:59], v[88:91]
  v_mfma_f32_16x16x32_bf16 v[92:95], a[60:63], v[60:63], v[92:95]
  s_mul_i32 s14, s6, 1376
  s_add_u32 s14, s14, s10
  s_lshl_b32 s14, s14, 8
  v_pk_mul_f32 v[64:65], v[64:65], v[8:9] op_sel:[0,0] op_sel_hi:[1,0]
  v_pk_mul_f32 v[66:67], v[66:67], v[8:9] op_sel:[0,0] op_sel_hi:[1,0]
  v_cvt_pk_bf16_f32 v48, v64, v66
  v_cvt_pk_bf16_f32 v49, v65, v67
  v_pk_max_i16 v48, v48, 0
  v_lshlrev_b32 v52, 16, v49
  v_and_b32 v53, 0xffff0000, v49
  v_lshlrev_b32 v50, 16, v48
  v_and_b32 v51, 0xffff0000, v48
  v_mul_f32 v50, v50, v52
  v_mul_f32 v51, v51, v53
  v_cvt_pk_bf16_f32 v32, v50, v51
  v_pk_mul_f32 v[68:69], v[68:69], v[10:11] op_sel:[0,0] op_sel_hi:[1,0]
  v_pk_mul_f32 v[70:71], v[70:71], v[10:11] op_sel:[0,0] op_sel_hi:[1,0]
  v_cvt_pk_bf16_f32 v56, v68, v70
  v_cvt_pk_bf16_f32 v57, v69, v71
  v_pk_max_i16 v56, v56, 0
  v_lshlrev_b32 v60, 16, v57
  v_and_b32 v61, 0xffff0000, v57
  v_lshlrev_b32 v58, 16, v56
  v_and_b32 v59, 0xffff0000, v56
  v_mul_f32 v58, v58, v60
  v_mul_f32 v59, v59, v61
  v_cvt_pk_bf16_f32 v33, v58, v59
  v_pk_mul_f32 v[72:73], v[72:73], v[12:13] op_sel:[0,0] op_sel_hi:[1,0]
  v_pk_mul_f32 v[74:75], v[74:75], v[12:13] op_sel:[0,0] op_sel_hi:[1,0]
  v_cvt_pk_bf16_f32 v48, v72, v74
  v_cvt_pk_bf16_f32 v49, v73, v75
  v_pk_max_i16 v48, v48, 0
  v_lshlrev_b32 v52, 16, v49
  v_and_b32 v53, 0xffff0000, v49
  v_lshlrev_b32 v50, 16, v48
  v_and_b32 v51, 0xffff0000, v48
  v_mul_f32 v50, v50, v52
  v_mul_f32 v51, v51, v53
  v_cvt_pk_bf16_f32 v34, v50, v51
  v_pk_mul_f32 v[76:77], v[76:77], v[14:15] op_sel:[0,0] op_sel_hi:[1,0]
  v_pk_mul_f32 v[78:79], v[78:79], v[14:15] op_sel:[0,0] op_sel_hi:[1,0]
  v_cvt_pk_bf16_f32 v56, v76, v78
  v_cvt_pk_bf16_f32 v57, v77, v79
  v_pk_max_i16 v56, v56, 0
  v_lshlrev_b32 v60, 16, v57
  v_and_b32 v61, 0xffff0000, v57
  v_lshlrev_b32 v58, 16, v56
  v_and_b32 v59, 0xffff0000, v56
  v_mul_f32 v58, v58, v60
  v_mul_f32 v59, v59, v61
  v_cvt_pk_bf16_f32 v35, v58, v59
  v_permlane16_swap_b32 v32, v33
  s_nop 0
  v_permlane16_swap_b32 v34, v35
  s_nop 1
  v_permlane32_swap_b32 v32, v34
  v_permlane32_swap_b32 v33, v35
  buffer_store_dwordx4 v[32:35], v30, s[56:59], s14 offen sc1
  s_add_u32 s14, s14, 176128
  v_pk_mul_f32 v[80:81], v[80:81], v[16:17] op_sel:[0,0] op_sel_hi:[1,0]
  v_pk_mul_f32 v[82:83], v[82:83], v[16:17] op_sel:[0,0] op_sel_hi:[1,0]
  v_cvt_pk_bf16_f32 v48, v80, v82
  v_cvt_pk_bf16_f32 v49, v81, v83
  v_pk_max_i16 v48, v48, 0
  v_lshlrev_b32 v52, 16, v49
  v_and_b32 v53, 0xffff0000, v49
  v_lshlrev_b32 v50, 16, v48
  v_and_b32 v51, 0xffff0000, v48
  v_mul_f32 v50, v50, v52
  v_mul_f32 v51, v51, v53
  v_cvt_pk_bf16_f32 v36, v50, v51
  v_pk_mul_f32 v[84:85], v[84:85], v[18:19] op_sel:[0,0] op_sel_hi:[1,0]
  v_pk_mul_f32 v[86:87], v[86:87], v[18:19] op_sel:[0,0] op_sel_hi:[1,0]
  v_cvt_pk_bf16_f32 v56, v84, v86
  v_cvt_pk_bf16_f32 v57, v85, v87
  v_pk_max_i16 v56, v56, 0
  v_lshlrev_b32 v60, 16, v57
  v_and_b32 v61, 0xffff0000, v57
  v_lshlrev_b32 v58, 16, v56
  v_and_b32 v59, 0xffff0000, v56
  v_mul_f32 v58, v58, v60
  v_mul_f32 v59, v59, v61
  v_cvt_pk_bf16_f32 v37, v58, v59
  v_pk_mul_f32 v[88:89], v[88:89], v[20:21] op_sel:[0,0] op_sel_hi:[1,0]
  v_pk_mul_f32 v[90:91], v[90:91], v[20:21] op_sel:[0,0] op_sel_hi:[1,0]
  v_cvt_pk_bf16_f32 v48, v88, v90
  v_cvt_pk_bf16_f32 v49, v89, v91
  v_pk_max_i16 v48, v48, 0
  v_lshlrev_b32 v52, 16, v49
  v_and_b32 v53, 0xffff0000, v49
  v_lshlrev_b32 v50, 16, v48
  v_and_b32 v51, 0xffff0000, v48
  v_mul_f32 v50, v50, v52
  v_mul_f32 v51, v51, v53
  v_cvt_pk_bf16_f32 v38, v50, v51
  v_pk_mul_f32 v[92:93], v[92:93], v[22:23] op_sel:[0,0] op_sel_hi:[1,0]
  v_pk_mul_f32 v[94:95], v[94:95], v[22:23] op_sel:[0,0] op_sel_hi:[1,0]
  v_cvt_pk_bf16_f32 v56, v92, v94
  v_cvt_pk_bf16_f32 v57, v93, v95
  v_pk_max_i16 v56, v56, 0
  v_lshlrev_b32 v60, 16, v57
  v_and_b32 v61, 0xffff0000, v57
  v_lshlrev_b32 v58, 16, v56
  v_and_b32 v59, 0xffff0000, v56
  v_mul_f32 v58, v58, v60
  v_mul_f32 v59, v59, v61
  v_cvt_pk_bf16_f32 v39, v58, v59
  v_permlane16_swap_b32 v36, v37
  s_nop 0
  v_permlane16_swap_b32 v38, v39
  s_nop 1
  v_permlane32_swap_b32 v36, v38
  v_permlane32_swap_b32 v37, v39
  buffer_store_dwordx4 v[36:39], v30, s[56:59], s14 offen sc1
  s_branch G1_DONE
G1_16:
  ds_read_b128 v[32:35], v28 offset:0
  ds_read_b128 v[36:39], v28 offset:17536
  ds_read_b128 v[40:43], v28 offset:35072
  ds_read_b128 v[44:47], v28 offset:52608
  ds_read_b128 v[48:51], v29 offset:0
  ds_read_b128 v[52:55], v29 offset:17536
  ds_read_b128 v[56:59], v29 offset:35072
  ds_read_b128 v[60:63], v29 offset:52608
  s_waitcnt lgkmcnt(4)
  v_mfma_f32_16x16x32_bf16 v[64:67], a[0:3], v[32:35], 0
  v_mfma_f32_16x16x32_bf16 v[68:71], a[0:3], v[36:39], 0
  v_mfma_f32_16x16x32_bf16 v[72:75], a[0:3], v[40:43], 0
  v_mfma_f32_16x16x32_bf16 v[76:79], a[0:3], v[44:47], 0
  ds_read_b128 v[32:35], v28 offset:64
  ds_read_b128 v[36:39], v28 offset:17600
  ds_read_b128 v[40:43], v28 offset:35136
  ds_read_b128 v[44:47], v28 offset:52672
  s_waitcnt lgkmcnt(4)
  v_mfma_f32_16x16x32_bf16 v[80:83], a[0:3], v[48:51], 0
  v_mfma_f32_16x16x32_bf16 v[84:87], a[0:3], v[52:55], 0
  v_mfma_f32_16x16x32_bf16 v[88:91], a[0:3], v[56:59], 0
  v_mfma_f32_16x16x32_bf16 v[92:95], a[0:3], v[60:63], 0
  ds_read_b128 v[48:51], v29 offset:64
  ds_read_b128 v[52:55], v29 offset:17600
  ds_read_b128 v[56:59], v29 offset:35136
  ds_read_b128 v[60:63], v29 offset:52672
  s_waitcnt lgkmcnt(4)
  v_mfma_f32_16x16x32_bf16 v[64:67], a[4:7], v[32:35], v[64:67]
  v_mfma_f32_16x16x32_bf16 v[68:71], a[4:7], v[36:39], v[68:71]
  v_mfma_f32_16x16x32_bf16 v[72:75], a[4:7], v[40:43], v[72:75]
  v_mfma_f32_16x16x32_bf16 v[76:79], a[4:7], v[44:47], v[76:79]
  ds_read_b128 v[32:35], v28 offset:128
  ds_read_b128 v[36:39], v28 offset:17664
  ds_read_b128 v[40:43], v28 offset:35200
  ds_read_b128 v[44:47], v28 offset:52736
  s_waitcnt lgkmcnt(4)
  v_mfma_f32_16x16x32_bf16 v[80:83], a[4:7], v[48:51], v[80:83]
  v_mfma_f32_16x16x32_bf16 v[84:87], a[4:7], v[52:55], v[84:87]
  v_mfma_f32_16x16x32_bf16 v[88:91], a[4:7], v[56:59], v[88:91]
  v_mfma_f32_16x16x32_bf16 v[92:95], a[4:7], v[60:63], v[92:95]
  ds_read_b128 v[8:11], v23
  ds_read_b128 v[12:15], v23 offset:512
  ds_read_b128 v[16:19], v23 offset:1024
  s_waitcnt lgkmcnt(0)
  v_add_f32 v12, v12, v16
  v_add_f32 v13, v13, v17
  v_add_f32 v14, v14, v18
  v_add_f32 v15, v15, v19
  v_add_f32 v8, v8, v12
  v_add_f32 v9, v9, v13
  v_add_f32 v10, v10, v14
  v_add_f32 v11, v11, v15
  ds_read_b128 v[12:15], v23 offset:1536
  ds_read_b128 v[16:19], v23 offset:2048
  s_waitcnt lgkmcnt(0)
  v_add_f32 v12, v12, v16
  v_add_f32 v13, v13, v17
  v_add_f32 v14, v14, v18
  v_add_f32 v15, v15, v19
  v_add_f32 v8, v8, v12
  v_add_f32 v9, v9, v13
  v_add_f32 v10, v10, v14
  v_add_f32 v11, v11, v15
  ds_read_b128 v[12:15], v23 offset:2560
  ds_read_b128 v[16:19], v23 offset:3072
  s_waitcnt lgkmcnt(0)
  v_add_f32 v12, v12, v16
  v_add_f32 v13, v13, v17
  v_add_f32 v14, v14, v18
  v_add_f32 v15, v15, v19
  v_add_f32 v8, v8, v12
  v_add_f32 v9, v9, v13
  v_add_f32 v10, v10, v14
  v_add_f32 v11, v11, v15
  ds_read_b128 v[12:15], v23 offset:3584
  v_mov_b32 v16, 0
  v_mov_b32 v17, 0
  v_mov_b32 v18, 0
  v_mov_b32 v19, 0
  s_waitcnt lgkmcnt(0)
  v_add_f32 v8, v8, v12
  v_add_f32 v9, v9, v13
  v_add_f32 v10, v10, v14
  v_add_f32 v11, v11, v15
  v_mul_f32 v24, v24, v24
  v_mul_f32 v25, v25, v25
  v_mul_f32 v26, v26, v26
  v_mul_f32 v27, v27, v27
  s_mov_b32 s15, 0x3b000000
  v_fma_f32 v8, v8, s15, -v24
  v_fma_f32 v9, v9, s15, -v25
  v_fma_f32 v10, v10, s15, -v26
  v_fma_f32 v11, v11, s15, -v27
  v_max_f32 v8, 0, v8
  v_max_f32 v9, 0, v9
  v_max_f32 v10, 0, v10
  v_max_f32 v11, 0, v11
  v_cvt_pk_bf16_f32 v8, v8, v8
  v_cvt_pk_bf16_f32 v9, v9, v9
  v_cvt_pk_bf16_f32 v10, v10, v10
  v_cvt_pk_bf16_f32 v11, v11, v11
  v_and_b32 v8, 0xffff0000, v8
  v_and_b32 v9, 0xffff0000, v9
  v_and_b32 v10, 0xffff0000, v10
  v_and_b32 v11, 0xffff0000, v11
  v_add_f32 v8, 0x3727c5ac, v8
  v_add_f32 v9, 0x3727c5ac, v9
  v_add_f32 v10, 0x3727c5ac, v10
  v_add_f32 v11, 0x3727c5ac, v11
  v_cvt_pk_bf16_f32 v8, v8, v8
  v_cvt_pk_bf16_f32 v9, v9, v9
  v_cvt_pk_bf16_f32 v10, v10, v10
  v_cvt_pk_bf16_f32 v11, v11, v11
  v_and_b32 v8, 0xffff0000, v8
  v_and_b32 v9, 0xffff0000, v9
  v_and_b32 v10, 0xffff0000, v10
  v_and_b32 v11, 0xffff0000, v11
  v_sqrt_f32 v8, v8
  v_sqrt_f32 v9, v9
  v_sqrt_f32 v10, v10
  v_sqrt_f32 v11, v11
  v_cvt_pk_bf16_f32 v8, v8, v8
  v_cvt_pk_bf16_f32 v9, v9, v9
  v_cvt_pk_bf16_f32 v10, v10, v10
  v_cvt_pk_bf16_f32 v11, v11, v11
  v_and_b32 v8, 0xffff0000, v8
  v_and_b32 v9, 0xffff0000, v9
  v_and_b32 v10, 0xffff0000, v10
  v_and_b32 v11, 0xffff0000, v11
  v_rcp_f32 v8, v8
  v_rcp_f32 v9, v9
  v_rcp_f32 v10, v10
  v_rcp_f32 v11, v11
  v_add_u32 v22, 4096, v23
  ds_write_b128 v22, v[8:11]
  s_waitcnt lgkmcnt(0)
  ds_read_b32 v8, v31 offset:0
  ds_read_b32 v10, v31 offset:64
  ds_read_b32 v12, v31 offset:128
  ds_read_b32 v14, v31 offset:192
  ds_read_b32 v16, v31 offset:256
  ds_read_b32 v18, v31 offset:320
  ds_read_b32 v20, v31 offset:384
  ds_read_b32 v22, v31 offset:448
  s_waitcnt lgkmcnt(0)
  ds_read_b128 v[48:51], v29 offset:128
  ds_read_b128 v[52:55], v29 offset:17664
  ds_read_b128 v[56:59], v29 offset:35200
  ds_read_b128 v[60:63], v29 offset:52736
  s_waitcnt lgkmcnt(4)
  v_mfma_f32_16x16x32_bf16 v[64:67], a[8:11], v[32:35], v[64:67]
  v_mfma_f32_16x16x32_bf16 v[68:71], a[8:11], v[36:39], v[68:71]
  v_mfma_f32_16x16x32_bf16 v[72:75], a[8:11], v[40:43], v[72:75]
  v_mfma_f32_16x16x32_bf16 v[76:79], a[8:11], v[44:47], v[76:79]
  ds_read_b128 v[32:35], v28 offset:192
  ds_read_b128 v[36:39], v28 offset:17728
  ds_read_b128 v[40:43], v28 offset:35264
  ds_read_b128 v[44:47], v28 offset:52800
  s_waitcnt lgkmcnt(4)
  v_mfma_f32_16x16x32_bf16 v[80:83], a[8:11], v[48:51], v[80:83]
  v_mfma_f32_16x16x32_bf16 v[84:87], a[8:11], v[52:55], v[84:87]
  v_mfma_f32_16x16x32_bf16 v[88:91], a[8:11], v[56:59], v[88:91]
  v_mfma_f32_16x16x32_bf16 v[92:95], a[8:11], v[60:63], v[92:95]
  ds_read_b128 v[48:51], v29 offset:192
  ds_read_b128 v[52:55], v29 offset:17728
  ds_read_b128 v[56:59], v29 offset:35264
  ds_read_b128 v[60:63], v29 offset:52800
  s_waitcnt lgkmcnt(4)
  v_mfma_f32_16x16x32_bf16 v[64:67], a[12:15], v[32:35], v[64:67]
  v_mfma_f32_16x16x32_bf16 v[68:71], a[12:15], v[36:39], v[68:71]
  v_mfma_f32_16x16x32_bf16 v[72:75], a[12:15], v[40:43], v[72:75]
  v_mfma_f32_16x16x32_bf16 v[76:79], a[12:15], v[44:47], v[76:79]
  ds_read_b128 v[32:35], v28 offset:256
  ds_read_b128 v[36:39], v28 offset:17792
  ds_read_b128 v[40:43], v28 offset:35328
  ds_read_b128 v[44:47], v28 offset:52864
  s_waitcnt lgkmcnt(4)
  v_mfma_f32_16x16x32_bf16 v[80:83], a[12:15], v[48:51], v[80:83]
  v_mfma_f32_16x16x32_bf16 v[84:87], a[12:15], v[52:55], v[84:87]
  v_mfma_f32_16x16x32_bf16 v[88:91], a[12:15], v[56:59], v[88:91]
  v_mfma_f32_16x16x32_bf16 v[92:95], a[12:15], v[60:63], v[92:95]
  buffer_load_dwordx4 a[0:3], v7, s[48:51], s60 offen offset:0 sc1
  buffer_load_dwordx4 a[4:7], v7, s[48:51], s61 offen offset:0 sc1
  buffer_load_dwordx4 a[8:11], v7, s[48:51], s62 offen offset:0 sc1
  buffer_load_dwordx4 a[12:15], v7, s[48:51], s63 offen offset:0 sc1
  s_add_u32 s60, s60, 8192
  s_add_u32 s61, s61, 8192
  s_add_u32 s62, s62, 8192
  s_add_u32 s63, s63, 8192
  buffer_load_dwordx4 a[64:67], v7, s[48:51], s60 offen offset:0 sc1
  buffer_load_dwordx4 a[68:71], v7, s[48:51], s61 offen offset:0 sc1
  buffer_load_dwordx4 a[72:75], v7, s[48:51], s62 offen offset:0 sc1
  buffer_load_dwordx4 a[76:79], v7, s[48:51], s63 offen offset:0 sc1
  s_add_u32 s60, s60, 8192
  s_add_u32 s61, s61, 8192
  s_add_u32 s62, s62, 8192
  s_add_u32 s63, s63, 8192
  ds_read_b128 v[48:51], v29 offset:256
  ds_read_b128 v[52:55], v29 offset:17792
  ds_read_b128 v[56:59], v29 offset:35328
  ds_read_b128 v[60:63], v29 offset:52864
  s_waitcnt lgkmcnt(4)
  v_mfma_f32_16x16x32_bf16 v[64:67], a[16:19], v[32:35], v[64:67]
  v_mfma_f32_16x16x32_bf16 v[68:71], a[16:19], v[36:39], v[68:71]
  v_mfma_f32_16x16x32_bf16 v[72:75], a[16:19], v[40:43], v[72:75]
  v_mfma_f32_16x16x32_bf16 v[76:79], a[16:19], v[44:47], v[76:79]
  ds_read_b128 v[32:35], v28 offset:320
  ds_read_b128 v[36:39], v28 offset:17856
  ds_read_b128 v[40:43], v28 offset:35392
  ds_read_b128 v[44:47], v28 offset:52928
  s_waitcnt lgkmcnt(4)
  v_mfma_f32_16x16x32_bf16 v[80:83], a[16:19], v[48:51], v[80:83]
  v_mfma_f32_16x16x32_bf16 v[84:87], a[16:19], v[52:55], v[84:87]
  v_mfma_f32_16x16x32_bf16 v[88:91], a[16:19], v[56:59], v[88:91]
  v_mfma_f32_16x16x32_bf16 v[92:95], a[16:19], v[60:63], v[92:95]
  ds_read_b128 v[48:51], v29 offset:320
  ds_read_b128 v[52:55], v29 offset:17856
  ds_read_b128 v[56:59], v29 offset:35392
  ds_read_b128 v[60:63], v29 offset:52928
  s_waitcnt lgkmcnt(4)
  v_mfma_f32_16x16x32_bf16 v[64:67], a[20:23], v[32:35], v[64:67]
  v_mfma_f32_16x16x32_bf16 v[68:71], a[20:23], v[36:39], v[68:71]
  v_mfma_f32_16x16x32_bf16 v[72:75], a[20:23], v[40:43], v[72:75]
  v_mfma_f32_16x16x32_bf16 v[76:79], a[20:23], v[44:47], v[76:79]
  ds_read_b128 v[32:35], v28 offset:384
  ds_read_b128 v[36:39], v28 offset:17920
  ds_read_b128 v[40:43], v28 offset:35456
  ds_read_b128 v[44:47], v28 offset:52992
  s_waitcnt lgkmcnt(4)
  v_mfma_f32_16x16x32_bf16 v[80:83], a[20:23], v[48:51], v[80:83]
  v_mfma_f32_16x16x32_bf16 v[84:87], a[20:23], v[52:55], v[84:87]
  v_mfma_f32_16x16x32_bf16 v[88:91], a[20:23], v[56:59], v[88:91]
  v_mfma_f32_16x16x32_bf16 v[92:95], a[20:23], v[60:63], v[92:95]
  ds_read_b128 v[48:51], v29 offset:384
  ds_read_b128 v[52:55], v29 offset:17920
  ds_read_b128 v[56:59], v29 offset:35456
  ds_read_b128 v[60:63], v29 offset:52992
  s_waitcnt lgkmcnt(4)
  v_mfma_f32_16x16x32_bf16 v[64:67], a[24:27], v[32:35], v[64:67]
  v_mfma_f32_16x16x32_bf16 v[68:71], a[24:27], v[36:39], v[68:71]
  v_mfma_f32_16x16x32_bf16 v[72:75], a[24:27], v[40:43], v[72:75]
  v_mfma_f32_16x16x32_bf16 v[76:79], a[24:27], v[44:47], v[76:79]
  ds_read_b128 v[32:35], v28 offset:448
  ds_read_b128 v[36:39], v28 offset:17984
  ds_read_b128 v[40:43], v28 offset:35520
  ds_read_b128 v[44:47], v28 offset:53056
  s_waitcnt lgkmcnt(4)
  v_mfma_f32_16x16x32_bf16 v[80:83], a[24:27], v[48:51], v[80:83]
  v_mfma_f32_16x16x32_bf16 v[84:87], a[24:27], v[52:55], v[84:87]
  v_mfma_f32_16x16x32_bf16 v[88:91], a[24:27], v[56:59], v[88:91]
  v_mfma_f32_16x16x32_bf16 v[92:95], a[24:27], v[60:63], v[92:95]
  ds_read_b128 v[48:51], v29 offset:448
  ds_read_b128 v[52:55], v29 offset:17984
  ds_read_b128 v[56:59], v29 offset:35520
  ds_read_b128 v[60:63], v29 offset:53056
  s_waitcnt lgkmcnt(4)
  v_mfma_f32_16x16x32_bf16 v[64:67], a[28:31], v[32:35], v[64:67]
  v_mfma_f32_16x16x32_bf16 v[68:71], a[28:31], v[36:39], v[68:71]
  v_mfma_f32_16x16x32_bf16 v[72:75], a[28:31], v[40:43], v[72:75]
  v_mfma_f32_16x16x32_bf16 v[76:79], a[28:31], v[44:47], v[76:79]
  ds_read_b128 v[32:35], v28 offset:512
  ds_read_b128 v[36:39], v28 offset:18048
  ds_read_b128 v[40:43], v28 offset:35584
  ds_read_b128 v[44:47], v28 offset:53120
  s_waitcnt lgkmcnt(4)
  v_mfma_f32_16x16x32_bf16 v[80:83], a[28:31], v[48:51], v[80:83]
  v_mfma_f32_16x16x32_bf16 v[84:87], a[28:31], v[52:55], v[84:87]
  v_mfma_f32_16x16x32_bf16 v[88:91], a[28:31], v[56:59], v[88:91]
  v_mfma_f32_16x16x32_bf16 v[92:95], a[28:31], v[60:63], v[92:95]
  buffer_load_dwordx4 a[16:19], v7, s[48:51], s60 offen offset:0 sc1
  buffer_load_dwordx4 a[20:23], v7, s[48:51], s61 offen offset:0 sc1
  buffer_load_dwordx4 a[24:27], v7, s[48:51], s62 offen offset:0 sc1
  buffer_load_dwordx4 a[28:31], v7, s[48:51], s63 offen offset:0 sc1
  s_add_u32 s60, s60, 8192
  s_add_u32 s61, s61, 8192
  s_add_u32 s62, s62, 8192
  s_add_u32 s63, s63, 8192
  buffer_load_dwordx4 a[80:83], v7, s[48:51], s60 offen offset:0 sc1
  buffer_load_dwordx4 a[84:87], v7, s[48:51], s61 offen offset:0 sc1
  buffer_load_dwordx4 a[88:91], v7, s[48:51], s62 offen offset:0 sc1
  buffer_load_dwordx4 a[92:95], v7, s[48:51], s63 offen offset:0 sc1
  s_add_u32 s60, s60, 8192
  s_add_u32 s61, s61, 8192
  s_add_u32 s62, s62, 8192
  s_add_u32 s63, s63, 8192
  ds_read_b128 v[48:51], v29 offset:512
  ds_read_b128 v[52:55], v29 offset:18048
  ds_read_b128 v[56:59], v29 offset:35584
  ds_read_b128 v[60:63], v29 offset:53120
  s_waitcnt lgkmcnt(4)
  v_mfma_f32_16x16x32_bf16 v[64:67], a[32:35], v[32:35], v[64:67]
  v_mfma_f32_16x16x32_bf16 v[68:71], a[32:35], v[36:39], v[68:71]
  v_mfma_f32_16x16x32_bf16 v[72:75], a[32:35], v[40:43], v[72:75]
  v_mfma_f32_16x16x32_bf16 v[76:79], a[32:35], v[44:47], v[76:79]
  ds_read_b128 v[32:35], v28 offset:576
  ds_read_b128 v[36:39], v28 offset:18112
  ds_read_b128 v[40:43], v28 offset:35648
  ds_read_b128 v[44:47], v28 offset:53184
  s_waitcnt lgkmcnt(4)
  v_mfma_f32_16x16x32_bf16 v[80:83], a[32:35], v[48:51], v[80:83]
  v_mfma_f32_16x16x32_bf16 v[84:87], a[32:35], v[52:55], v[84:87]
  v_mfma_f32_16x16x32_bf16 v[88:91], a[32:35], v[56:59], v[88:91]
  v_mfma_f32_16x16x32_bf16 v[92:95], a[32:35], v[60:63], v[92:95]
  ds_read_b128 v[48:51], v29 offset:576
  ds_read_b128 v[52:55], v29 offset:18112
  ds_read_b128 v[56:59], v29 offset:35648
  ds_read_b128 v[60:63], v29 offset:53184
  s_waitcnt lgkmcnt(4)
  v_mfma_f32_16x16x32_bf16 v[64:67], a[36:39], v[32:35], v[64:67]
  v_mfma_f32_16x16x32_bf16 v[68:71], a[36:39], v[36:39], v[68:71]
  v_mfma_f32_16x16x32_bf16 v[72:75], a[36:39], v[40:43], v[72:75]
  v_mfma_f32_16x16x32_bf16 v[76:79], a[36:39], v[44:47], v[76:79]
  ds_read_b128 v[32:35], v28 offset:640
  ds_read_b128 v[36:39], v28 offset:18176
  ds_read_b128 v[40:43], v28 offset:35712
  ds_read_b128 v[44:47], v28 offset:53248
  s_waitcnt lgkmcnt(4)
  v_mfma_f32_16x16x32_bf16 v[80:83], a[36:39], v[48:51], v[80:83]
  v_mfma_f32_16x16x32_bf16 v[84:87], a[36:39], v[52:55], v[84:87]
  v_mfma_f32_16x16x32_bf16 v[88:91], a[36:39], v[56:59], v[88:91]
  v_mfma_f32_16x16x32_bf16 v[92:95], a[36:39], v[60:63], v[92:95]
  ds_read_b128 v[48:51], v29 offset:640
  ds_read_b128 v[52:55], v29 offset:18176
  ds_read_b128 v[56:59], v29 offset:35712
  ds_read_b128 v[60:63], v29 offset:53248
  s_waitcnt lgkmcnt(4)
  v_mfma_f32_16x16x32_bf16 v[64:67], a[40:43], v[32:35], v[64:67]
  v_mfma_f32_16x16x32_bf16 v[68:71], a[40:43], v[36:39], v[68:71]
  v_mfma_f32_16x16x32_bf16 v[72:75], a[40:43], v[40:43], v[72:75]
  v_mfma_f32_16x16x32_bf16 v[76:79], a[40:43], v[44:47], v[76:79]
  ds_read_b128 v[32:35], v28 offset:704
  ds_read_b128 v[36:39], v28 offset:18240
  ds_read_b128 v[40:43], v28 offset:35776
  ds_read_b128 v[44:47], v28 offset:53312
  s_waitcnt lgkmcnt(4)
  v_mfma_f32_16x16x32_bf16 v[80:83], a[40:43], v[48:51], v[80:83]
  v_mfma_f32_16x16x32_bf16 v[84:87], a[40:43], v[52:55], v[84:87]
  v_mfma_f32_16x16x32_bf16 v[88:91], a[40:43], v[56:59], v[88:91]
  v_mfma_f32_16x16x32_bf16 v[92:95], a[40:43], v[60:63], v[92:95]
  ds_read_b128 v[48:51], v29 offset:704
  ds_read_b128 v[52:55], v29 offset:18240
  ds_read_b128 v[56:59], v29 offset:35776
  ds_read_b128 v[60:63], v29 offset:53312
  s_waitcnt lgkmcnt(4)
  v_mfma_f32_16x16x32_bf16 v[64:67], a[44:47], v[32:35], v[64:67]
  v_mfma_f32_16x16x32_bf16 v[68:71], a[44:47], v[36:39], v[68:71]
  v_mfma_f32_16x16x32_bf16 v[72:75], a[44:47], v[40:43], v[72:75]
  v_mfma_f32_16x16x32_bf16 v[76:79], a[44:47], v[44:47], v[76:79]
  ds_read_b128 v[32:35], v28 offset:768
  ds_read_b128 v[36:39], v28 offset:18304
  ds_read_b128 v[40:43], v28 offset:35840
  ds_read_b128 v[44:47], v28 offset:53376
  s_waitcnt lgkmcnt(4)
  v_mfma_f32_16x16x32_bf16 v[80:83], a[44:47], v[48:51], v[80:83]
  v_mfma_f32_16x16x32_bf16 v[84:87], a[44:47], v[52:55], v[84:87]
  v_mfma_f32_16x16x32_bf16 v[88:91], a[44:47], v[56:59], v[88:91]
  v_mfma_f32_16x16x32_bf16 v[92:95], a[44:47], v[60:63], v[92:95]
  buffer_load_dwordx4 a[32:35], v7, s[48:51], s60 offen offset:0 sc1
  buffer_load_dwordx4 a[36:39], v7, s[48:51], s61 offen offset:0 sc1
  buffer_load_dwordx4 a[40:43], v7, s[48:51], s62 offen offset:0 sc1
  buffer_load_dwordx4 a[44:47], v7, s[48:51], s63 offen offset:0 sc1
  s_add_u32 s60, s60, 8192
  s_add_u32 s61, s61, 8192
  s_add_u32 s62, s62, 8192
  s_add_u32 s63, s63, 8192
  ds_read_b128 v[48:51], v29 offset:768
  ds_read_b128 v[52:55], v29 offset:18304
  ds_read_b128 v[56:59], v29 offset:35840
  ds_read_b128 v[60:63], v29 offset:53376
  s_waitcnt lgkmcnt(4)
  v_mfma_f32_16x16x32_bf16 v[64:67], a[48:51], v[32:35], v[64:67]
  v_mfma_f32_16x16x32_bf16 v[68:71], a[48:51], v[36:39], v[68:71]
  v_mfma_f32_16x16x32_bf16 v[72:75], a[48:51], v[40:43], v[72:75]
  v_mfma_f32_16x16x32_bf16 v[76:79], a[48:51], v[44:47], v[76:79]
  ds_read_b128 v[32:35], v28 offset:832
  ds_read_b128 v[36:39], v28 offset:18368
  ds_read_b128 v[40:43], v28 offset:35904
  ds_read_b128 v[44:47], v28 offset:53440
  s_waitcnt lgkmcnt(4)
  v_mfma_f32_16x16x32_bf16 v[80:83], a[48:51], v[48:51], v[80:83]
  v_mfma_f32_16x16x32_bf16 v[84:87], a[48:51], v[52:55], v[84:87]
  v_mfma_f32_16x16x32_bf16 v[88:91], a[48:51], v[56:59], v[88:91]
  v_mfma_f32_16x16x32_bf16 v[92:95], a[48:51], v[60:63], v[92:95]
  ds_read_b128 v[48:51], v29 offset:832
  ds_read_b128 v[52:55], v29 offset:18368
  ds_read_b128 v[56:59], v29 offset:35904
  ds_read_b128 v[60:63], v29 offset:53440
  s_waitcnt lgkmcnt(4)
  v_mfma_f32_16x16x32_bf16 v[64:67], a[52:55], v[32:35], v[64:67]
  v_mfma_f32_16x16x32_bf16 v[68:71], a[52:55], v[36:39], v[68:71]
  v_mfma_f32_16x16x32_bf16 v[72:75], a[52:55], v[40:43], v[72:75]
  v_mfma_f32_16x16x32_bf16 v[76:79], a[52:55], v[44:47], v[76:79]
  ds_read_b128 v[32:35], v28 offset:896
  ds_read_b128 v[36:39], v28 offset:18432
  ds_read_b128 v[40:43], v28 offset:35968
  ds_read_b128 v[44:47], v28 offset:53504
  s_waitcnt lgkmcnt(4)
  v_mfma_f32_16x16x32_bf16 v[80:83], a[52:55], v[48:51], v[80:83]
  v_mfma_f32_16x16x32_bf16 v[84:87], a[52:55], v[52:55], v[84:87]
  v_mfma_f32_16x16x32_bf16 v[88:91], a[52:55], v[56:59], v[88:91]
  v_mfma_f32_16x16x32_bf16 v[92:95], a[52:55], v[60:63], v[92:95]
  ds_read_b128 v[48:51], v29 offset:896
  ds_read_b128 v[52:55], v29 offset:18432
  ds_read_b128 v[56:59], v29 offset:35968
  ds_read_b128 v[60:63], v29 offset:53504
  s_waitcnt lgkmcnt(4)
  v_mfma_f32_16x16x32_bf16 v[64:67], a[56:59], v[32:35], v[64:67]
  v_mfma_f32_16x16x32_bf16 v[68:71], a[56:59], v[36:39], v[68:71]
  v_mfma_f32_16x16x32_bf16 v[72:75], a[56:59], v[40:43], v[72:75]
  v_mfma_f32_16x16x32_bf16 v[76:79], a[56:59], v[44:47], v[76:79]
  ds_read_b128 v[32:35], v28 offset:960
  ds_read_b128 v[36:39], v28 offset:18496
  ds_read_b128 v[40:43], v28 offset:36032
  ds_read_b128 v[44:47], v28 offset:53568
  s_waitcnt lgkmcnt(4)
  v_mfma_f32_16x16x32_bf16 v[80:83], a[56:59], v[48:51], v[80:83]
  v_mfma_f32_16x16x32_bf16 v[84:87], a[56:59], v[52:55], v[84:87]
  v_mfma_f32_16x16x32_bf16 v[88:91], a[56:59], v[56:59], v[88:91]
  v_mfma_f32_16x16x32_bf16 v[92:95], a[56:59], v[60:63], v[92:95]
  ds_read_b128 v[48:51], v29 offset:960
  ds_read_b128 v[52:55], v29 offset:18496
  ds_read_b128 v[56:59], v29 offset:36032
  ds_read_b128 v[60:63], v29 offset:53568
  s_waitcnt lgkmcnt(4)
  v_mfma_f32_16x16x32_bf16 v[64:67], a[60:63], v[32:35], v[64:67]
  v_mfma_f32_16x16x32_bf16 v[68:71], a[60:63], v[36:39], v[68:71]
  v_mfma_f32_16x16x32_bf16 v[72:75], a[60:63], v[40:43], v[72:75]
  v_mfma_f32_16x16x32_bf16 v[76:79], a[60:63], v[44:47], v[76:79]
  s_waitcnt lgkmcnt(0)
  v_mfma_f32_16x16x32_bf16 v[80:83], a[60:63], v[48:51], v[80:83]
  v_mfma_f32_16x16x32_bf16 v[84:87], a[60:63], v[52:55], v[84:87]
  v_mfma_f32_16x16x32_bf16 v[88:91], a[60:63], v[56:59], v[88:91]
  v_mfma_f32_16x16x32_bf16 v[92:95], a[60:63], v[60:63], v[92:95]
  buffer_load_dwordx4 a[48:51], v7, s[48:51], s60 offen offset:0 sc1
  buffer_load_dwordx4 a[52:55], v7, s[48:51], s61 offen offset:0 sc1
  buffer_load_dwordx4 a[56:59], v7, s[48:51], s62 offen offset:0 sc1
  buffer_load_dwordx4 a[60:63], v7, s[48:51], s63 offen offset:0 sc1
  s_add_u32 s60, s60, 8192
  s_add_u32 s61, s61, 8192
  s_add_u32 s62, s62, 8192
  s_add_u32 s63, s63, 8192
  s_mul_i32 s14, s6, 1376
  s_add_u32 s14, s14, s10
  s_lshl_b32 s14, s14, 8
  v_pk_mul_f32 v[64:65], v[64:65], v[8:9] op_sel:[0,0] op_sel_hi:[1,0]
  v_pk_mul_f32 v[66:67], v[66:67], v[8:9] op_sel:[0,0] op_sel_hi:[1,0]
  v_cvt_pk_bf16_f32 v48, v64, v66
  v_cvt_pk_bf16_f32 v49, v65, v67
  v_pk_max_i16 v48, v48, 0
  v_lshlrev_b32 v52, 16, v49
  v_and_b32 v53, 0xffff0000, v49
  v_lshlrev_b32 v50, 16, v48
  v_and_b32 v51, 0xffff0000, v48
  v_mul_f32 v50, v50, v52
  v_mul_f32 v51, v51, v53
  v_cvt_pk_bf16_f32 v32, v50, v51
  v_pk_mul_f32 v[68:69], v[68:69], v[10:11] op_sel:[0,0] op_sel_hi:[1,0]
  v_pk_mul_f32 v[70:71], v[70:71], v[10:11] op_sel:[0,0] op_sel_hi:[1,0]
  v_cvt_pk_bf16_f32 v56, v68, v70
  v_cvt_pk_bf16_f32 v57, v69, v71
  v_pk_max_i16 v56, v56, 0
  v_lshlrev_b32 v60, 16, v57
  v_and_b32 v61, 0xffff0000, v57
  v_lshlrev_b32 v58, 16, v56
  v_and_b32 v59, 0xffff0000, v56
  v_mul_f32 v58, v58, v60
  v_mul_f32 v59, v59, v61
  v_cvt_pk_bf16_f32 v33, v58, v59
  v_pk_mul_f32 v[72:73], v[72:73], v[12:13] op_sel:[0,0] op_sel_hi:[1,0]
  v_pk_mul_f32 v[74:75], v[74:75], v[12:13] op_sel:[0,0] op_sel_hi:[1,0]
  v_cvt_pk_bf16_f32 v48, v72, v74
  v_cvt_pk_bf16_f32 v49, v73, v75
  v_pk_max_i16 v48, v48, 0
  v_lshlrev_b32 v52, 16, v49
  v_and_b32 v53, 0xffff0000, v49
  v_lshlrev_b32 v50, 16, v48
  v_and_b32 v51, 0xffff0000, v48
  v_mul_f32 v50, v50, v52
  v_mul_f32 v51, v51, v53
  v_cvt_pk_bf16_f32 v34, v50, v51
  v_pk_mul_f32 v[76:77], v[76:77], v[14:15] op_sel:[0,0] op_sel_hi:[1,0]
  v_pk_mul_f32 v[78:79], v[78:79], v[14:15] op_sel:[0,0] op_sel_hi:[1,0]
  v_cvt_pk_bf16_f32 v56, v76, v78
  v_cvt_pk_bf16_f32 v57, v77, v79
  v_pk_max_i16 v56, v56, 0
  v_lshlrev_b32 v60, 16, v57
  v_and_b32 v61, 0xffff0000, v57
  v_lshlrev_b32 v58, 16, v56
  v_and_b32 v59, 0xffff0000, v56
  v_mul_f32 v58, v58, v60
  v_mul_f32 v59, v59, v61
  v_cvt_pk_bf16_f32 v35, v58, v59
  v_permlane16_swap_b32 v32, v33
  s_nop 0
  v_permlane16_swap_b32 v34, v35
  s_nop 1
  v_permlane32_swap_b32 v32, v34
  v_permlane32_swap_b32 v33, v35
  buffer_store_dwordx4 v[32:35], v30, s[56:59], s14 offen sc1
  s_add_u32 s14, s14, 176128
  v_pk_mul_f32 v[80:81], v[80:81], v[16:17] op_sel:[0,0] op_sel_hi:[1,0]
  v_pk_mul_f32 v[82:83], v[82:83], v[16:17] op_sel:[0,0] op_sel_hi:[1,0]
  v_cvt_pk_bf16_f32 v48, v80, v82
  v_cvt_pk_bf16_f32 v49, v81, v83
  v_pk_max_i16 v48, v48, 0
  v_lshlrev_b32 v52, 16, v49
  v_and_b32 v53, 0xffff0000, v49
  v_lshlrev_b32 v50, 16, v48
  v_and_b32 v51, 0xffff0000, v48
  v_mul_f32 v50, v50, v52
  v_mul_f32 v51, v51, v53
  v_cvt_pk_bf16_f32 v36, v50, v51
  v_pk_mul_f32 v[84:85], v[84:85], v[18:19] op_sel:[0,0] op_sel_hi:[1,0]
  v_pk_mul_f32 v[86:87], v[86:87], v[18:19] op_sel:[0,0] op_sel_hi:[1,0]
  v_cvt_pk_bf16_f32 v56, v84, v86
  v_cvt_pk_bf16_f32 v57, v85, v87
  v_pk_max_i16 v56, v56, 0
  v_lshlrev_b32 v60, 16, v57
  v_and_b32 v61, 0xffff0000, v57
  v_lshlrev_b32 v58, 16, v56
  v_and_b32 v59, 0xffff0000, v56
  v_mul_f32 v58, v58, v60
  v_mul_f32 v59, v59, v61
  v_cvt_pk_bf16_f32 v37, v58, v59
  v_pk_mul_f32 v[88:89], v[88:89], v[20:21] op_sel:[0,0] op_sel_hi:[1,0]
  v_pk_mul_f32 v[90:91], v[90:91], v[20:21] op_sel:[0,0] op_sel_hi:[1,0]
  v_cvt_pk_bf16_f32 v48, v88, v90
  v_cvt_pk_bf16_f32 v49, v89, v91
  v_pk_max_i16 v48, v48, 0
  v_lshlrev_b32 v52, 16, v49
  v_and_b32 v53, 0xffff0000, v49
  v_lshlrev_b32 v50, 16, v48
  v_and_b32 v51, 0xffff0000, v48
  v_mul_f32 v50, v50, v52
  v_mul_f32 v51, v51, v53
  v_cvt_pk_bf16_f32 v38, v50, v51
  v_pk_mul_f32 v[92:93], v[92:93], v[22:23] op_sel:[0,0] op_sel_hi:[1,0]
  v_pk_mul_f32 v[94:95], v[94:95], v[22:23] op_sel:[0,0] op_sel_hi:[1,0]
  v_cvt_pk_bf16_f32 v56, v92, v94
  v_cvt_pk_bf16_f32 v57, v93, v95
  v_pk_max_i16 v56, v56, 0
  v_lshlrev_b32 v60, 16, v57
  v_and_b32 v61, 0xffff0000, v57
  v_lshlrev_b32 v58, 16, v56
  v_and_b32 v59, 0xffff0000, v56
  v_mul_f32 v58, v58, v60
  v_mul_f32 v59, v59, v61
  v_cvt_pk_bf16_f32 v39, v58, v59
  v_permlane16_swap_b32 v36, v37
  s_nop 0
  v_permlane16_swap_b32 v38, v39
  s_nop 1
  v_permlane32_swap_b32 v36, v38
  v_permlane32_swap_b32 v37, v39
  buffer_store_dwordx4 v[36:39], v30, s[56:59], s14 offen sc1
  s_branch G1_DONE
G1_TWO:
  ds_read_b128 v[32:35], v28 offset:0
  ds_read_b128 v[36:39], v28 offset:17536
  ds_read_b128 v[40:43], v28 offset:35072
  ds_read_b128 v[44:47], v28 offset:52608
  ds_read_b128 v[48:51], v29 offset:0
  ds_read_b128 v[52:55], v29 offset:17536
  ds_read_b128 v[56:59], v29 offset:35072
  ds_read_b128 v[60:63], v29 offset:52608
  s_waitcnt lgkmcnt(4)
  v_mfma_f32_16x16x32_bf16 v[64:67], a[0:3], v[32:35], 0
  v_mfma_f32_16x16x32_bf16 v[96:99], a[64:67], v[32:35], 0
  v_mfma_f32_16x16x32_bf16 v[68:71], a[0:3], v[36:39], 0
  v_mfma_f32_16x16x32_bf16 v[100:103], a[64:67], v[36:39], 0
  v_mfma_f32_16x16x32_bf16 v[72:75], a[0:3], v[40:43], 0
  v_mfma_f32_16x16x32_bf16 v[104:107], a[64:67], v[40:43], 0
  v_mfma_f32_16x16x32_bf16 v[76:79], a[0:3], v[44:47], 0
  v_mfma_f32_16x16x32_bf16 v[108:111], a[64:67], v[44:47], 0
  ds_read_b128 v[32:35], v28 offset:64
  ds_read_b128 v[36:39], v28 offset:17600
  ds_read_b128 v[40:43], v28 offset:35136
  ds_read_b128 v[44:47], v28 offset:52672
  s_waitcnt lgkmcnt(4)
  v_mfma_f32_16x16x32_bf16 v[80:83], a[0:3], v[48:51], 0
  v_mfma_f32_16x16x32_bf16 v[112:115], a[64:67], v[48:51], 0
  v_mfma_f32_16x16x32_bf16 v[84:87], a[0:3], v[52:55], 0
  v_mfma_f32_16x16x32_bf16 v[116:119], a[64:67], v[52:55], 0
  v_mfma_f32_16x16x32_bf16 v[88:91], a[0:3], v[56:59], 0
  v_mfma_f32_16x16x32_bf16 v[120:123], a[64:67], v[56:59], 0
  v_mfma_f32_16x16x32_bf16 v[92:95], a[0:3], v[60:63], 0
  v_mfma_f32_16x16x32_bf16 v[124:127], a[64:67], v[60:63], 0
  ds_read_b128 v[48:51], v29 offset:64
  ds_read_b128 v[52:55], v29 offset:17600
  ds_read_b128 v[56:59], v29 offset:35136
  ds_read_b128 v[60:63], v29 offset:52672
  s_waitcnt lgkmcnt(4)
  v_mfma_f32_16x16x32_bf16 v[64:67], a[4:7], v[32:35], v[64:67]
  v_mfma_f32_16x16x32_bf16 v[96:99], a[68:71], v[32:35], v[96:99]
  v_mfma_f32_16x16x32_bf16 v[68:71], a[4:7], v[36:39], v[68:71]
  v_mfma_f32_16x16x32_bf16 v[100:103], a[68:71], v[36:39], v[100:103]
  v_mfma_f32_16x16x32_bf16 v[72:75], a[4:7], v[40:43], v[72:75]
  v_mfma_f32_16x16x32_bf16 v[104:107], a[68:71], v[40:43], v[104:107]
  v_mfma_f32_16x16x32_bf16 v[76:79], a[4:7], v[44:47], v[76:79]
  v_mfma_f32_16x16x32_bf16 v[108:111], a[68:71], v[44:47], v[108:111]
  ds_read_b128 v[32:35], v28 offset:128
  ds_read_b128 v[36:39], v28 offset:17664
  ds_read_b128 v[40:43], v28 offset:35200
  ds_read_b128 v[44:47], v28 offset:52736
  s_waitcnt lgkmcnt(4)
  v_mfma_f32_16x16x32_bf16 v[80:83], a[4:7], v[48:51], v[80:83]
  v_mfma_f32_16x16x32_bf16 v[112:115], a[68:71], v[48:51], v[112:115]
  v_mfma_f32_16x16x32_bf16 v[84:87], a[4:7], v[52:55], v[84:87]
  v_mfma_f32_16x16x32_bf16 v[116:119], a[68:71], v[52:55], v[116:119]
  v_mfma_f32_16x16x32_bf16 v[88:91], a[4:7], v[56:59], v[88:91]
  v_mfma_f32_16x16x32_bf16 v[120:123], a[68:71], v[56:59], v[120:123]
  v_mfma_f32_16x16x32_bf16 v[92:95], a[4:7], v[60:63], v[92:95]
  v_mfma_f32_16x16x32_bf16 v[124:127], a[68:71], v[60:63], v[124:127]
  ds_read_b128 v[8:11], v23
  ds_read_b128 v[12:15], v23 offset:512
  ds_read_b128 v[16:19], v23 offset:1024
  s_waitcnt lgkmcnt(0)
  v_add_f32 v12, v12, v16
  v_add_f32 v13, v13, v17
  v_add_f32 v14, v14, v18
  v_add_f32 v15, v15, v19
  v_add_f32 v8, v8, v12
  v_add_f32 v9, v9, v13
  v_add_f32 v10, v10, v14
  v_add_f32 v11, v11, v15
  ds_read_b128 v[12:15], v23 offset:1536
  ds_read_b128 v[16:19], v23 offset:2048
  s_waitcnt lgkmcnt(0)
  v_add_f32 v12, v12, v16
  v_add_f32 v13, v13, v17
  v_add_f32 v14, v14, v18
  v_add_f32 v15, v15, v19
  v_add_f32 v8, v8, v12
  v_add_f32 v9, v9, v13
  v_add_f32 v10, v10, v14
  v_add_f32 v11, v11, v15
  ds_read_b128 v[12:15], v23 offset:2560
  ds_read_b128 v[16:19], v23 offset:3072
  s_waitcnt lgkmcnt(0)
  v_add_f32 v12, v12, v16
  v_add_f32 v13, v13, v17
  v_add_f32 v14, v14, v18
  v_add_f32 v15, v15, v19
  v_add_f32 v8, v8, v12
  v_add_f32 v9, v9, v13
  v_add_f32 v10, v10, v14
  v_add_f32 v11, v11, v15
  ds_read_b128 v[12:15], v23 offset:3584
  v_mov_b32 v16, 0
  v_mov_b32 v17, 0
  v_mov_b32 v18, 0
  v_mov_b32 v19, 0
  s_waitcnt lgkmcnt(0)
  v_add_f32 v8, v8, v12
  v_add_f32 v9, v9, v13
  v_add_f32 v10, v10, v14
  v_add_f32 v11, v11, v15
  v_mul_f32 v24, v24, v24
  v_mul_f32 v25, v25, v25
  v_mul_f32 v26, v26, v26
  v_mul_f32 v27, v27, v27
  s_mov_b32 s15, 0x3b000000
  v_fma_f32 v8, v8, s15, -v24
  v_fma_f32 v9, v9, s15, -v25
  v_fma_f32 v10, v10, s15, -v26
  v_fma_f32 v11, v11, s15, -v27
  v_max_f32 v8, 0, v8
  v_max_f32 v9, 0, v9
  v_max_f32 v10, 0, v10
  v_max_f32 v11, 0, v11
  v_cvt_pk_bf16_f32 v8, v8, v8
  v_cvt_pk_bf16_f32 v9, v9, v9
  v_cvt_pk_bf16_f32 v10, v10, v10
  v_cvt_pk_bf16_f32 v11, v11, v11
  v_and_b32 v8, 0xffff0000, v8
  v_and_b32 v9, 0xffff0000, v9
  v_and_b32 v10, 0xffff0000, v10
  v_and_b32 v11, 0xffff0000, v11
  v_add_f32 v8, 0x3727c5ac, v8
  v_add_f32 v9, 0x3727c5ac, v9
  v_add_f32 v10, 0x3727c5ac, v10
  v_add_f32 v11, 0x3727c5ac, v11
  v_cvt_pk_bf16_f32 v8, v8, v8
  v_cvt_pk_bf16_f32 v9, v9, v9
  v_cvt_pk_bf16_f32 v10, v10, v10
  v_cvt_pk_bf16_f32 v11, v11, v11
  v_and_b32 v8, 0xffff0000, v8
  v_and_b32 v9, 0xffff0000, v9
  v_and_b32 v10, 0xffff0000, v10
  v_and_b32 v11, 0xffff0000, v11
  v_sqrt_f32 v8, v8
  v_sqrt_f32 v9, v9
  v_sqrt_f32 v10, v10
  v_sqrt_f32 v11, v11
  v_cvt_pk_bf16_f32 v8, v8, v8
  v_cvt_pk_bf16_f32 v9, v9, v9
  v_cvt_pk_bf16_f32 v10, v10, v10
  v_cvt_pk_bf16_f32 v11, v11, v11
  v_and_b32 v8, 0xffff0000, v8
  v_and_b32 v9, 0xffff0000, v9
  v_and_b32 v10, 0xffff0000, v10
  v_and_b32 v11, 0xffff0000, v11
  v_rcp_f32 v8, v8
  v_rcp_f32 v9, v9
  v_rcp_f32 v10, v10
  v_rcp_f32 v11, v11
  v_add_u32 v22, 4096, v23
  ds_write_b128 v22, v[8:11]
  s_waitcnt lgkmcnt(0)
  ds_read_b32 v8, v31 offset:0
  ds_read_b32 v10, v31 offset:64
  ds_read_b32 v12, v31 offset:128
  ds_read_b32 v14, v31 offset:192
  ds_read_b32 v16, v31 offset:256
  ds_read_b32 v18, v31 offset:320
  ds_read_b32 v20, v31 offset:384
  ds_read_b32 v22, v31 offset:448
  s_waitcnt lgkmcnt(0)
  ds_read_b128 v[48:51], v29 offset:128
  ds_read_b128 v[52:55], v29 offset:17664
  ds_read_b128 v[56:59], v29 offset:35200
  ds_read_b128 v[60:63], v29 offset:52736
  s_waitcnt lgkmcnt(4)
  v_mfma_f32_16x16x32_bf16 v[64:67], a[8:11], v[32:35], v[64:67]
  v_mfma_f32_16x16x32_bf16 v[96:99], a[72:75], v[32:35], v[96:99]
  v_mfma_f32_16x16x32_bf16 v[68:71], a[8:11], v[36:39], v[68:71]
  v_mfma_f32_16x16x32_bf16 v[100:103], a[72:75], v[36:39], v[100:103]
  v_mfma_f32_16x16x32_bf16 v[72:75], a[8:11], v[40:43], v[72:75]
  v_mfma_f32_16x16x32_bf16 v[104:107], a[72:75], v[40:43], v[104:107]
  v_mfma_f32_16x16x32_bf16 v[76:79], a[8:11], v[44:47], v[76:79]
  v_mfma_f32_16x16x32_bf16 v[108:111], a[72:75], v[44:47], v[108:111]
  ds_read_b128 v[32:35], v28 offset:192
  ds_read_b128 v[36:39], v28 offset:17728
  ds_read_b128 v[40:43], v28 offset:35264
  ds_read_b128 v[44:47], v28 offset:52800
  s_waitcnt lgkmcnt(4)
  v_mfma_f32_16x16x32_bf16 v[80:83], a[8:11], v[48:51], v[80:83]
  v_mfma_f32_16x16x32_bf16 v[112:115], a[72:75], v[48:51], v[112:115]
  v_mfma_f32_16x16x32_bf16 v[84:87], a[8:11], v[52:55], v[84:87]
  v_mfma_f32_16x16x32_bf16 v[116:119], a[72:75], v[52:55], v[116:119]
  v_mfma_f32_16x16x32_bf16 v[88:91], a[8:11], v[56:59], v[88:91]
  v_mfma_f32_16x16x32_bf16 v[120:123], a[72:75], v[56:59], v[120:123]
  v_mfma_f32_16x16x32_bf16 v[92:95], a[8:11], v[60:63], v[92:95]
  v_mfma_f32_16x16x32_bf16 v[124:127], a[72:75], v[60:63], v[124:127]
  ds_read_b128 v[48:51], v29 offset:192
  ds_read_b128 v[52:55], v29 offset:17728
  ds_read_b128 v[56:59], v29 offset:35264
  ds_read_b128 v[60:63], v29 offset:52800
  s_waitcnt lgkmcnt(4)
  v_mfma_f32_16x16x32_bf16 v[64:67], a[12:15], v[32:35], v[64:67]
  v_mfma_f32_16x16x32_bf16 v[96:99], a[76:79], v[32:35], v[96:99]
  v_mfma_f32_16x16x32_bf16 v[68:71], a[12:15], v[36:39], v[68:71]
  v_mfma_f32_16x16x32_bf16 v[100:103], a[76:79], v[36:39], v[100:103]
  v_mfma_f32_16x16x32_bf16 v[72:75], a[12:15], v[40:43], v[72:75]
  v_mfma_f32_16x16x32_bf16 v[104:107], a[76:79], v[40:43], v[104:107]
  v_mfma_f32_16x16x32_bf16 v[76:79], a[12:15], v[44:47], v[76:79]
  v_mfma_f32_16x16x32_bf16 v[108:111], a[76:79], v[44:47], v[108:111]
  ds_read_b128 v[32:35], v28 offset:256
  ds_read_b128 v[36:39], v28 offset:17792
  ds_read_b128 v[40:43], v28 offset:35328
  ds_read_b128 v[44:47], v28 offset:52864
  s_waitcnt lgkmcnt(4)
  v_mfma_f32_16x16x32_bf16 v[80:83], a[12:15], v[48:51], v[80:83]
  v_mfma_f32_16x16x32_bf16 v[112:115], a[76:79], v[48:51], v[112:115]
  v_mfma_f32_16x16x32_bf16 v[84:87], a[12:15], v[52:55], v[84:87]
  v_mfma_f32_16x16x32_bf16 v[116:119], a[76:79], v[52:55], v[116:119]
  v_mfma_f32_16x16x32_bf16 v[88:91], a[12:15], v[56:59], v[88:91]
  v_mfma_f32_16x16x32_bf16 v[120:123], a[76:79], v[56:59], v[120:123]
  v_mfma_f32_16x16x32_bf16 v[92:95], a[12:15], v[60:63], v[92:95]
  v_mfma_f32_16x16x32_bf16 v[124:127], a[76:79], v[60:63], v[124:127]
  buffer_load_dwordx4 a[0:3], v7, s[48:51], s60 offen offset:0 sc1
  buffer_load_dwordx4 a[4:7], v7, s[48:51], s61 offen offset:0 sc1
  buffer_load_dwordx4 a[8:11], v7, s[48:51], s62 offen offset:0 sc1
  buffer_load_dwordx4 a[12:15], v7, s[48:51], s63 offen offset:0 sc1
  s_add_u32 s60, s60, 8192
  s_add_u32 s61, s61, 8192
  s_add_u32 s62, s62, 8192
  s_add_u32 s63, s63, 8192
  buffer_load_dwordx4 a[64:67], v7, s[48:51], s60 offen offset:0 sc1
  buffer_load_dwordx4 a[68:71], v7, s[48:51], s61 offen offset:0 sc1
  buffer_load_dwordx4 a[72:75], v7, s[48:51], s62 offen offset:0 sc1
  buffer_load_dwordx4 a[76:79], v7, s[48:51], s63 offen offset:0 sc1
  s_add_u32 s60, s60, 8192
  s_add_u32 s61, s61, 8192
  s_add_u32 s62, s62, 8192
  s_add_u32 s63, s63, 8192
  ds_read_b128 v[48:51], v29 offset:256
  ds_read_b128 v[52:55], v29 offset:17792
  ds_read_b128 v[56:59], v29 offset:35328
  ds_read_b128 v[60:63], v29 offset:52864
  s_waitcnt lgkmcnt(4)
  v_mfma_f32_16x16x32_bf16 v[64:67], a[16:19], v[32:35], v[64:67]
  v_mfma_f32_16x16x32_bf16 v[96:99], a[80:83], v[32:35], v[96:99]
  v_mfma_f32_16x16x32_bf16 v[68:71], a[16:19], v[36:39], v[68:71]
  v_mfma_f32_16x16x32_bf16 v[100:103], a[80:83], v[36:39], v[100:103]
  v_mfma_f32_16x16x32_bf16 v[72:75], a[16:19], v[40:43], v[72:75]
  v_mfma_f32_16x16x32_bf16 v[104:107], a[80:83], v[40:43], v[104:107]
  v_mfma_f32_16x16x32_bf16 v[76:79], a[16:19], v[44:47], v[76:79]
  v_mfma_f32_16x16x32_bf16 v[108:111], a[80:83], v[44:47], v[108:111]
  ds_read_b128 v[32:35], v28 offset:320
  ds_read_b128 v[36:39], v28 offset:17856
  ds_read_b128 v[40:43], v28 offset:35392
  ds_read_b128 v[44:47], v28 offset:52928
  s_waitcnt lgkmcnt(4)
  v_mfma_f32_16x16x32_bf16 v[80:83], a[16:19], v[48:51], v[80:83]
  v_mfma_f32_16x16x32_bf16 v[112:115], a[80:83], v[48:51], v[112:115]
  v_mfma_f32_16x16x32_bf16 v[84:87], a[16:19], v[52:55], v[84:87]
  v_mfma_f32_16x16x32_bf16 v[116:119], a[80:83], v[52:55], v[116:119]
  v_mfma_f32_16x16x32_bf16 v[88:91], a[16:19], v[56:59], v[88:91]
  v_mfma_f32_16x16x32_bf16 v[120:123], a[80:83], v[56:59], v[120:123]
  v_mfma_f32_16x16x32_bf16 v[92:95], a[16:19], v[60:63], v[92:95]
  v_mfma_f32_16x16x32_bf16 v[124:127], a[80:83], v[60:63], v[124:127]
  ds_read_b128 v[48:51], v29 offset:320
  ds_read_b128 v[52:55], v29 offset:17856
  ds_read_b128 v[56:59], v29 offset:35392
  ds_read_b128 v[60:63], v29 offset:52928
  s_waitcnt lgkmcnt(4)
  v_mfma_f32_16x16x32_bf16 v[64:67], a[20:23], v[32:35], v[64:67]
  v_mfma_f32_16x16x32_bf16 v[96:99], a[84:87], v[32:35], v[96:99]
  v_mfma_f32_16x16x32_bf16 v[68:71], a[20:23], v[36:39], v[68:71]
  v_mfma_f32_16x16x32_bf16 v[100:103], a[84:87], v[36:39], v[100:103]
  v_mfma_f32_16x16x32_bf16 v[72:75], a[20:23], v[40:43], v[72:75]
  v_mfma_f32_16x16x32_bf16 v[104:107], a[84:87], v[40:43], v[104:107]
  v_mfma_f32_16x16x32_bf16 v[76:79], a[20:23], v[44:47], v[76:79]
  v_mfma_f32_16x16x32_bf16 v[108:111], a[84:87], v[44:47], v[108:111]
  ds_read_b128 v[32:35], v28 offset:384
  ds_read_b128 v[36:39], v28 offset:17920
  ds_read_b128 v[40:43], v28 offset:35456
  ds_read_b128 v[44:47], v28 offset:52992
  s_waitcnt lgkmcnt(4)
  v_mfma_f32_16x16x32_bf16 v[80:83], a[20:23], v[48:51], v[80:83]
  v_mfma_f32_16x16x32_bf16 v[112:115], a[84:87], v[48:51], v[112:115]
  v_mfma_f32_16x16x32_bf16 v[84:87], a[20:23], v[52:55], v[84:87]
  v_mfma_f32_16x16x32_bf16 v[116:119], a[84:87], v[52:55], v[116:119]
  v_mfma_f32_16x16x32_bf16 v[88:91], a[20:23], v[56:59], v[88:91]
  v_mfma_f32_16x16x32_bf16 v[120:123], a[84:87], v[56:59], v[120:123]
  v_mfma_f32_16x16x32_bf16 v[92:95], a[20:23], v[60:63], v[92:95]
  v_mfma_f32_16x16x32_bf16 v[124:127], a[84:87], v[60:63], v[124:127]
  ds_read_b128 v[48:51], v29 offset:384
  ds_read_b128 v[52:55], v29 offset:17920
  ds_read_b128 v[56:59], v29 offset:35456
  ds_read_b128 v[60:63], v29 offset:52992
  s_waitcnt lgkmcnt(4)
  v_mfma_f32_16x16x32_bf16 v[64:67], a[24:27], v[32:35], v[64:67]
  v_mfma_f32_16x16x32_bf16 v[96:99], a[88:91], v[32:35], v[96:99]
  v_mfma_f32_16x16x32_bf16 v[68:71], a[24:27], v[36:39], v[68:71]
  v_mfma_f32_16x16x32_bf16 v[100:103], a[88:91], v[36:39], v[100:103]
  v_mfma_f32_16x16x32_bf16 v[72:75], a[24:27], v[40:43], v[72:75]
  v_mfma_f32_16x16x32_bf16 v[104:107], a[88:91], v[40:43], v[104:107]
  v_mfma_f32_16x16x32_bf16 v[76:79], a[24:27], v[44:47], v[76:79]
  v_mfma_f32_16x16x32_bf16 v[108:111], a[88:91], v[44:47], v[108:111]
  ds_read_b128 v[32:35], v28 offset:448
  ds_read_b128 v[36:39], v28 offset:17984
  ds_read_b128 v[40:43], v28 offset:35520
  ds_read_b128 v[44:47], v28 offset:53056
  s_waitcnt lgkmcnt(4)
  v_mfma_f32_16x16x32_bf16 v[80:83], a[24:27], v[48:51], v[80:83]
  v_mfma_f32_16x16x32_bf16 v[112:115], a[88:91], v[48:51], v[112:115]
  v_mfma_f32_16x16x32_bf16 v[84:87], a[24:27], v[52:55], v[84:87]
  v_mfma_f32_16x16x32_bf16 v[116:119], a[88:91], v[52:55], v[116:119]
  v_mfma_f32_16x16x32_bf16 v[88:91], a[24:27], v[56:59], v[88:91]
  v_mfma_f32_16x16x32_bf16 v[120:123], a[88:91], v[56:59], v[120:123]
  v_mfma_f32_16x16x32_bf16 v[92:95], a[24:27], v[60:63], v[92:95]
  v_mfma_f32_16x16x32_bf16 v[124:127], a[88:91], v[60:63], v[124:127]
  ds_read_b128 v[48:51], v29 offset:448
  ds_read_b128 v[52:55], v29 offset:17984
  ds_read_b128 v[56:59], v29 offset:35520
  ds_read_b128 v[60:63], v29 offset:53056
  s_waitcnt lgkmcnt(4)
  v_mfma_f32_16x16x32_bf16 v[64:67], a[28:31], v[32:35], v[64:67]
  v_mfma_f32_16x16x32_bf16 v[96:99], a[92:95], v[32:35], v[96:99]
  v_mfma_f32_16x16x32_bf16 v[68:71], a[28:31], v[36:39], v[68:71]
  v_mfma_f32_16x16x32_bf16 v[100:103], a[92:95], v[36:39], v[100:103]
  v_mfma_f32_16x16x32_bf16 v[72:75], a[28:31], v[40:43], v[72:75]
  v_mfma_f32_16x16x32_bf16 v[104:107], a[92:95], v[40:43], v[104:107]
  v_mfma_f32_16x16x32_bf16 v[76:79], a[28:31], v[44:47], v[76:79]
  v_mfma_f32_16x16x32_bf16 v[108:111], a[92:95], v[44:47], v[108:111]
  ds_read_b128 v[32:35], v28 offset:512
  ds_read_b128 v[36:39], v28 offset:18048
  ds_read_b128 v[40:43], v28 offset:35584
  ds_read_b128 v[44:47], v28 offset:53120
  s_waitcnt lgkmcnt(4)
  v_mfma_f32_16x16x32_bf16 v[80:83], a[28:31], v[48:51], v[80:83]
  v_mfma_f32_16x16x32_bf16 v[112:115], a[92:95], v[48:51], v[112:115]
  v_mfma_f32_16x16x32_bf16 v[84:87], a[28:31], v[52:55], v[84:87]
  v_mfma_f32_16x16x32_bf16 v[116:119], a[92:95], v[52:55], v[116:119]
  v_mfma_f32_16x16x32_bf16 v[88:91], a[28:31], v[56:59], v[88:91]
  v_mfma_f32_16x16x32_bf16 v[120:123], a[92:95], v[56:59], v[120:123]
  v_mfma_f32_16x16x32_bf16 v[92:95], a[28:31], v[60:63], v[92:95]
  v_mfma_f32_16x16x32_bf16 v[124:127], a[92:95], v[60:63], v[124:127]
  buffer_load_dwordx4 a[16:19], v7, s[48:51], s60 offen offset:0 sc1
  buffer_load_dwordx4 a[20:23], v7, s[48:51], s61 offen offset:0 sc1
  buffer_load_dwordx4 a[24:27], v7, s[48:51], s62 offen offset:0 sc1
  buffer_load_dwordx4 a[28:31], v7, s[48:51], s63 offen offset:0 sc1
  s_add_u32 s60, s60, 8192
  s_add_u32 s61, s61, 8192
  s_add_u32 s62, s62, 8192
  s_add_u32 s63, s63, 8192
  buffer_load_dwordx4 a[80:83], v7, s[48:51], s60 offen offset:0 sc1
  buffer_load_dwordx4 a[84:87], v7, s[48:51], s61 offen offset:0 sc1
  buffer_load_dwordx4 a[88:91], v7, s[48:51], s62 offen offset:0 sc1
  buffer_load_dwordx4 a[92:95], v7, s[48:51], s63 offen offset:0 sc1
  s_add_u32 s60, s60, 8192
  s_add_u32 s61, s61, 8192
  s_add_u32 s62, s62, 8192
  s_add_u32 s63, s63, 8192
  ds_read_b128 v[48:51], v29 offset:512
  ds_read_b128 v[52:55], v29 offset:18048
  ds_read_b128 v[56:59], v29 offset:35584
  ds_read_b128 v[60:63], v29 offset:53120
  s_waitcnt lgkmcnt(4)
  v_mfma_f32_16x16x32_bf16 v[64:67], a[32:35], v[32:35], v[64:67]
  v_mfma_f32_16x16x32_bf16 v[96:99], a[96:99], v[32:35], v[96:99]
  v_mfma_f32_16x16x32_bf16 v[68:71], a[32:35], v[36:39], v[68:71]
  v_mfma_f32_16x16x32_bf16 v[100:103], a[96:99], v[36:39], v[100:103]
  v_mfma_f32_16x16x32_bf16 v[72:75], a[32:35], v[40:43], v[72:75]
  v_mfma_f32_16x16x32_bf16 v[104:107], a[96:99], v[40:43], v[104:107]
  v_mfma_f32_16x16x32_bf16 v[76:79], a[32:35], v[44:47], v[76:79]
  v_mfma_f32_16x16x32_bf16 v[108:111], a[96:99], v[44:47], v[108:111]
  ds_read_b128 v[32:35], v28 offset:576
  ds_read_b128 v[36:39], v28 offset:18112
  ds_read_b128 v[40:43], v28 offset:35648
  ds_read_b128 v[44:47], v28 offset:53184
  s_waitcnt lgkmcnt(4)
  v_mfma_f32_16x16x32_bf16 v[80:83], a[32:35], v[48:51], v[80:83]
  v_mfma_f32_16x16x32_bf16 v[112:115], a[96:99], v[48:51], v[112:115]
  v_mfma_f32_16x16x32_bf16 v[84:87], a[32:35], v[52:55], v[84:87]
  v_mfma_f32_16x16x32_bf16 v[116:119], a[96:99], v[52:55], v[116:119]
  v_mfma_f32_16x16x32_bf16 v[88:91], a[32:35], v[56:59], v[88:91]
  v_mfma_f32_16x16x32_bf16 v[120:123], a[96:99], v[56:59], v[120:123]
  v_mfma_f32_16x16x32_bf16 v[92:95], a[32:35], v[60:63], v[92:95]
  v_mfma_f32_16x16x32_bf16 v[124:127], a[96:99], v[60:63], v[124:127]
  ds_read_b128 v[48:51], v29 offset:576
  ds_read_b128 v[52:55], v29 offset:18112
  ds_read_b128 v[56:59], v29 offset:35648
  ds_read_b128 v[60:63], v29 offset:53184
  s_waitcnt lgkmcnt(4)
  v_mfma_f32_16x16x32_bf16 v[64:67], a[36:39], v[32:35], v[64:67]
  v_mfma_f32_16x16x32_bf16 v[96:99], a[100:103], v[32:35], v[96:99]
  v_mfma_f32_16x16x32_bf16 v[68:71], a[36:39], v[36:39], v[68:71]
  v_mfma_f32_16x16x32_bf16 v[100:103], a[100:103], v[36:39], v[100:103]
  v_mfma_f32_16x16x32_bf16 v[72:75], a[36:39], v[40:43], v[72:75]
  v_mfma_f32_16x16x32_bf16 v[104:107], a[100:103], v[40:43], v[104:107]
  v_mfma_f32_16x16x32_bf16 v[76:79], a[36:39], v[44:47], v[76:79]
  v_mfma_f32_16x16x32_bf16 v[108:111], a[100:103], v[44:47], v[108:111]
  ds_read_b128 v[32:35], v28 offset:640
  ds_read_b128 v[36:39], v28 offset:18176
  ds_read_b128 v[40:43], v28 offset:35712
  ds_read_b128 v[44:47], v28 offset:53248
  s_waitcnt lgkmcnt(4)
  v_mfma_f32_16x16x32_bf16 v[80:83], a[36:39], v[48:51], v[80:83]
  v_mfma_f32_16x16x32_bf16 v[112:115], a[100:103], v[48:51], v[112:115]
  v_mfma_f32_16x16x32_bf16 v[84:87], a[36:39], v[52:55], v[84:87]
  v_mfma_f32_16x16x32_bf16 v[116:119], a[100:103], v[52:55], v[116:119]
  v_mfma_f32_16x16x32_bf16 v[88:91], a[36:39], v[56:59], v[88:91]
  v_mfma_f32_16x16x32_bf16 v[120:123], a[100:103], v[56:59], v[120:123]
  v_mfma_f32_16x16x32_bf16 v[92:95], a[36:39], v[60:63], v[92:95]
  v_mfma_f32_16x16x32_bf16 v[124:127], a[100:103], v[60:63], v[124:127]
  ds_read_b128 v[48:51], v29 offset:640
  ds_read_b128 v[52:55], v29 offset:18176
  ds_read_b128 v[56:59], v29 offset:35712
  ds_read_b128 v[60:63], v29 offset:53248
  s_waitcnt lgkmcnt(4)
  v_mfma_f32_16x16x32_bf16 v[64:67], a[40:43], v[32:35], v[64:67]
  v_mfma_f32_16x16x32_bf16 v[96:99], a[104:107], v[32:35], v[96:99]
  v_mfma_f32_16x16x32_bf16 v[68:71], a[40:43], v[36:39], v[68:71]
  v_mfma_f32_16x16x32_bf16 v[100:103], a[104:107], v[36:39], v[100:103]
  v_mfma_f32_16x16x32_bf16 v[72:75], a[40:43], v[40:43], v[72:75]
  v_mfma_f32_16x16x32_bf16 v[104:107], a[104:107], v[40:43], v[104:107]
  v_mfma_f32_16x16x32_bf16 v[76:79], a[40:43], v[44:47], v[76:79]
  v_mfma_f32_16x16x32_bf16 v[108:111], a[104:107], v[44:47], v[108:111]
  ds_read_b128 v[32:35], v28 offset:704
  ds_read_b128 v[36:39], v28 offset:18240
  ds_read_b128 v[40:43], v28 offset:35776
  ds_read_b128 v[44:47], v28 offset:53312
  s_waitcnt lgkmcnt(4)
  v_mfma_f32_16x16x32_bf16 v[80:83], a[40:43], v[48:51], v[80:83]
  v_mfma_f32_16x16x32_bf16 v[112:115], a[104:107], v[48:51], v[112:115]
  v_mfma_f32_16x16x32_bf16 v[84:87], a[40:43], v[52:55], v[84:87]
  v_mfma_f32_16x16x32_bf16 v[116:119], a[104:107], v[52:55], v[116:119]
  v_mfma_f32_16x16x32_bf16 v[88:91], a[40:43], v[56:59], v[88:91]
  v_mfma_f32_16x16x32_bf16 v[120:123], a[104:107], v[56:59], v[120:123]
  v_mfma_f32_16x16x32_bf16 v[92:95], a[40:43], v[60:63], v[92:95]
  v_mfma_f32_16x16x32_bf16 v[124:127], a[104:107], v[60:63], v[124:127]
  ds_read_b128 v[48:51], v29 offset:704
  ds_read_b128 v[52:55], v29 offset:18240
  ds_read_b128 v[56:59], v29 offset:35776
  ds_read_b128 v[60:63], v29 offset:53312
  s_waitcnt lgkmcnt(4)
  v_mfma_f32_16x16x32_bf16 v[64:67], a[44:47], v[32:35], v[64:67]
  v_mfma_f32_16x16x32_bf16 v[96:99], a[108:111], v[32:35], v[96:99]
  v_mfma_f32_16x16x32_bf16 v[68:71], a[44:47], v[36:39], v[68:71]
  v_mfma_f32_16x16x32_bf16 v[100:103], a[108:111], v[36:39], v[100:103]
  v_mfma_f32_16x16x32_bf16 v[72:75], a[44:47], v[40:43], v[72:75]
  v_mfma_f32_16x16x32_bf16 v[104:107], a[108:111], v[40:43], v[104:107]
  v_mfma_f32_16x16x32_bf16 v[76:79], a[44:47], v[44:47], v[76:79]
  v_mfma_f32_16x16x32_bf16 v[108:111], a[108:111], v[44:47], v[108:111]
  ds_read_b128 v[32:35], v28 offset:768
  ds_read_b128 v[36:39], v28 offset:18304
  ds_read_b128 v[40:43], v28 offset:35840
  ds_read_b128 v[44:47], v28 offset:53376
  s_waitcnt lgkmcnt(4)
  v_mfma_f32_16x16x32_bf16 v[80:83], a[44:47], v[48:51], v[80:83]
  v_mfma_f32_16x16x32_bf16 v[112:115], a[108:111], v[48:51], v[112:115]
  v_mfma_f32_16x16x32_bf16 v[84:87], a[44:47], v[52:55], v[84:87]
  v_mfma_f32_16x16x32_bf16 v[116:119], a[108:111], v[52:55], v[116:119]
  v_mfma_f32_16x16x32_bf16 v[88:91], a[44:47], v[56:59], v[88:91]
  v_mfma_f32_16x16x32_bf16 v[120:123], a[108:111], v[56:59], v[120:123]
  v_mfma_f32_16x16x32_bf16 v[92:95], a[44:47], v[60:63], v[92:95]
  v_mfma_f32_16x16x32_bf16 v[124:127], a[108:111], v[60:63], v[124:127]
  buffer_load_dwordx4 a[32:35], v7, s[48:51], s60 offen offset:0 sc1
  buffer_load_dwordx4 a[36:39], v7, s[48:51], s61 offen offset:0 sc1
  buffer_load_dwordx4 a[40:43], v7, s[48:51], s62 offen offset:0 sc1
  buffer_load_dwordx4 a[44:47], v7, s[48:51], s63 offen offset:0 sc1
  s_add_u32 s60, s60, 8192
  s_add_u32 s61, s61, 8192
  s_add_u32 s62, s62, 8192
  s_add_u32 s63, s63, 8192
  ds_read_b128 v[48:51], v29 offset:768
  ds_read_b128 v[52:55], v29 offset:18304
  ds_read_b128 v[56:59], v29 offset:35840
  ds_read_b128 v[60:63], v29 offset:53376
  s_waitcnt lgkmcnt(4)
  v_mfma_f32_16x16x32_bf16 v[64:67], a[48:51], v[32:35], v[64:67]
  v_mfma_f32_16x16x32_bf16 v[96:99], a[112:115], v[32:35], v[96:99]
  v_mfma_f32_16x16x32_bf16 v[68:71], a[48:51], v[36:39], v[68:71]
  v_mfma_f32_16x16x32_bf16 v[100:103], a[112:115], v[36:39], v[100:103]
  v_mfma_f32_16x16x32_bf16 v[72:75], a[48:51], v[40:43], v[72:75]
  v_mfma_f32_16x16x32_bf16 v[104:107], a[112:115], v[40:43], v[104:107]
  v_mfma_f32_16x16x32_bf16 v[76:79], a[48:51], v[44:47], v[76:79]
  v_mfma_f32_16x16x32_bf16 v[108:111], a[112:115], v[44:47], v[108:111]
  ds_read_b128 v[32:35], v28 offset:832
  ds_read_b128 v[36:39], v28 offset:18368
  ds_read_b128 v[40:43], v28 offset:35904
  ds_read_b128 v[44:47], v28 offset:53440
  s_waitcnt lgkmcnt(4)
  v_mfma_f32_16x16x32_bf16 v[80:83], a[48:51], v[48:51], v[80:83]
  v_mfma_f32_16x16x32_bf16 v[112:115], a[112:115], v[48:51], v[112:115]
  v_mfma_f32_16x16x32_bf16 v[84:87], a[48:51], v[52:55], v[84:87]
  v_mfma_f32_16x16x32_bf16 v[116:119], a[112:115], v[52:55], v[116:119]
  v_mfma_f32_16x16x32_bf16 v[88:91], a[48:51], v[56:59], v[88:91]
  v_mfma_f32_16x16x32_bf16 v[120:123], a[112:115], v[56:59], v[120:123]
  v_mfma_f32_16x16x32_bf16 v[92:95], a[48:51], v[60:63], v[92:95]
  v_mfma_f32_16x16x32_bf16 v[124:127], a[112:115], v[60:63], v[124:127]
  ds_read_b128 v[48:51], v29 offset:832
  ds_read_b128 v[52:55], v29 offset:18368
  ds_read_b128 v[56:59], v29 offset:35904
  ds_read_b128 v[60:63], v29 offset:53440
  s_waitcnt lgkmcnt(4)
  v_mfma_f32_16x16x32_bf16 v[64:67], a[52:55], v[32:35], v[64:67]
  v_mfma_f32_16x16x32_bf16 v[96:99], a[116:119], v[32:35], v[96:99]
  v_mfma_f32_16x16x32_bf16 v[68:71], a[52:55], v[36:39], v[68:71]
  v_mfma_f32_16x16x32_bf16 v[100:103], a[116:119], v[36:39], v[100:103]
  v_mfma_f32_16x16x32_bf16 v[72:75], a[52:55], v[40:43], v[72:75]
  v_mfma_f32_16x16x32_bf16 v[104:107], a[116:119], v[40:43], v[104:107]
  v_mfma_f32_16x16x32_bf16 v[76:79], a[52:55], v[44:47], v[76:79]
  v_mfma_f32_16x16x32_bf16 v[108:111], a[116:119], v[44:47], v[108:111]
  ds_read_b128 v[32:35], v28 offset:896
  ds_read_b128 v[36:39], v28 offset:18432
  ds_read_b128 v[40:43], v28 offset:35968
  ds_read_b128 v[44:47], v28 offset:53504
  s_waitcnt lgkmcnt(4)
  v_mfma_f32_16x16x32_bf16 v[80:83], a[52:55], v[48:51], v[80:83]
  v_mfma_f32_16x16x32_bf16 v[112:115], a[116:119], v[48:51], v[112:115]
  v_mfma_f32_16x16x32_bf16 v[84:87], a[52:55], v[52:55], v[84:87]
  v_mfma_f32_16x16x32_bf16 v[116:119], a[116:119], v[52:55], v[116:119]
  v_mfma_f32_16x16x32_bf16 v[88:91], a[52:55], v[56:59], v[88:91]
  v_mfma_f32_16x16x32_bf16 v[120:123], a[116:119], v[56:59], v[120:123]
  v_mfma_f32_16x16x32_bf16 v[92:95], a[52:55], v[60:63], v[92:95]
  v_mfma_f32_16x16x32_bf16 v[124:127], a[116:119], v[60:63], v[124:127]
  ds_read_b128 v[48:51], v29 offset:896
  ds_read_b128 v[52:55], v29 offset:18432
  ds_read_b128 v[56:59], v29 offset:35968
  ds_read_b128 v[60:63], v29 offset:53504
  s_waitcnt lgkmcnt(4)
  v_mfma_f32_16x16x32_bf16 v[64:67], a[56:59], v[32:35], v[64:67]
  v_mfma_f32_16x16x32_bf16 v[96:99], a[120:123], v[32:35], v[96:99]
  v_mfma_f32_16x16x32_bf16 v[68:71], a[56:59], v[36:39], v[68:71]
  v_mfma_f32_16x16x32_bf16 v[100:103], a[120:123], v[36:39], v[100:103]
  v_mfma_f32_16x16x32_bf16 v[72:75], a[56:59], v[40:43], v[72:75]
  v_mfma_f32_16x16x32_bf16 v[104:107], a[120:123], v[40:43], v[104:107]
  v_mfma_f32_16x16x32_bf16 v[76:79], a[56:59], v[44:47], v[76:79]
  v_mfma_f32_16x16x32_bf16 v[108:111], a[120:123], v[44:47], v[108:111]
  ds_read_b128 v[32:35], v28 offset:960
  ds_read_b128 v[36:39], v28 offset:18496
  ds_read_b128 v[40:43], v28 offset:36032
  ds_read_b128 v[44:47], v28 offset:53568
  s_waitcnt lgkmcnt(4)
  v_mfma_f32_16x16x32_bf16 v[80:83], a[56:59], v[48:51], v[80:83]
  v_mfma_f32_16x16x32_bf16 v[112:115], a[120:123], v[48:51], v[112:115]
  v_mfma_f32_16x16x32_bf16 v[84:87], a[56:59], v[52:55], v[84:87]
  v_mfma_f32_16x16x32_bf16 v[116:119], a[120:123], v[52:55], v[116:119]
  v_mfma_f32_16x16x32_bf16 v[88:91], a[56:59], v[56:59], v[88:91]
  v_mfma_f32_16x16x32_bf16 v[120:123], a[120:123], v[56:59], v[120:123]
  v_mfma_f32_16x16x32_bf16 v[92:95], a[56:59], v[60:63], v[92:95]
  v_mfma_f32_16x16x32_bf16 v[124:127], a[120:123], v[60:63], v[124:127]
  ds_read_b128 v[48:51], v29 offset:960
  ds_read_b128 v[52:55], v29 offset:18496
  ds_read_b128 v[56:59], v29 offset:36032
  ds_read_b128 v[60:63], v29 offset:53568
  s_waitcnt lgkmcnt(4)
  v_mfma_f32_16x16x32_bf16 v[64:67], a[60:63], v[32:35], v[64:67]
  v_mfma_f32_16x16x32_bf16 v[96:99], a[124:127], v[32:35], v[96:99]
  v_mfma_f32_16x16x32_bf16 v[68:71], a[60:63], v[36:39], v[68:71]
  v_mfma_f32_16x16x32_bf16 v[100:103], a[124:127], v[36:39], v[100:103]
  v_mfma_f32_16x16x32_bf16 v[72:75], a[60:63], v[40:43], v[72:75]
  v_mfma_f32_16x16x32_bf16 v[104:107], a[124:127], v[40:43], v[104:107]
  v_mfma_f32_16x16x32_bf16 v[76:79], a[60:63], v[44:47], v[76:79]
  v_mfma_f32_16x16x32_bf16 v[108:111], a[124:127], v[44:47], v[108:111]
  s_waitcnt lgkmcnt(0)
  v_mfma_f32_16x16x32_bf16 v[80:83], a[60:63], v[48:51], v[80:83]
  v_mfma_f32_16x16x32_bf16 v[112:115], a[124:127], v[48:51], v[112:115]
  v_mfma_f32_16x16x32_bf16 v[84:87], a[60:63], v[52:55], v[84:87]
  v_mfma_f32_16x16x32_bf16 v[116:119], a[124:127], v[52:55], v[116:119]
  v_mfma_f32_16x16x32_bf16 v[88:91], a[60:63], v[56:59], v[88:91]
  v_mfma_f32_16x16x32_bf16 v[120:123], a[124:127], v[56:59], v[120:123]
  v_mfma_f32_16x16x32_bf16 v[92:95], a[60:63], v[60:63], v[92:95]
  v_mfma_f32_16x16x32_bf16 v[124:127], a[124:127], v[60:63], v[124:127]
  buffer_load_dwordx4 a[48:51], v7, s[48:51], s60 offen offset:0 sc1
  buffer_load_dwordx4 a[52:55], v7, s[48:51], s61 offen offset:0 sc1
  buffer_load_dwordx4 a[56:59], v7, s[48:51], s62 offen offset:0 sc1
  buffer_load_dwordx4 a[60:63], v7, s[48:51], s63 offen offset:0 sc1
  s_add_u32 s60, s60, 8192
  s_add_u32 s61, s61, 8192
  s_add_u32 s62, s62, 8192
  s_add_u32 s63, s63, 8192
  s_mul_i32 s14, s6, 1376
  s_add_u32 s14, s14, s10
  s_lshl_b32 s14, s14, 8
  v_pk_mul_f32 v[64:65], v[64:65], v[8:9] op_sel:[0,0] op_sel_hi:[1,0]
  v_pk_mul_f32 v[66:67], v[66:67], v[8:9] op_sel:[0,0] op_sel_hi:[1,0]
  v_cvt_pk_bf16_f32 v48, v64, v66
  v_cvt_pk_bf16_f32 v49, v65, v67
  v_pk_max_i16 v48, v48, 0
  v_lshlrev_b32 v52, 16, v49
  v_and_b32 v53, 0xffff0000, v49
  v_lshlrev_b32 v50, 16, v48
  v_and_b32 v51, 0xffff0000, v48
  v_mul_f32 v50, v50, v52
  v_mul_f32 v51, v51, v53
  v_cvt_pk_bf16_f32 v32, v50, v51
  v_pk_mul_f32 v[68:69], v[68:69], v[10:11] op_sel:[0,0] op_sel_hi:[1,0]
  v_pk_mul_f32 v[70:71], v[70:71], v[10:11] op_sel:[0,0] op_sel_hi:[1,0]
  v_cvt_pk_bf16_f32 v56, v68, v70
  v_cvt_pk_bf16_f32 v57, v69, v71
  v_pk_max_i16 v56, v56, 0
  v_lshlrev_b32 v60, 16, v57
  v_and_b32 v61, 0xffff0000, v57
  v_lshlrev_b32 v58, 16, v56
  v_and_b32 v59, 0xffff0000, v56
  v_mul_f32 v58, v58, v60
  v_mul_f32 v59, v59, v61
  v_cvt_pk_bf16_f32 v33, v58, v59
  v_pk_mul_f32 v[72:73], v[72:73], v[12:13] op_sel:[0,0] op_sel_hi:[1,0]
  v_pk_mul_f32 v[74:75], v[74:75], v[12:13] op_sel:[0,0] op_sel_hi:[1,0]
  v_cvt_pk_bf16_f32 v48, v72, v74
  v_cvt_pk_bf16_f32 v49, v73, v75
  v_pk_max_i16 v48, v48, 0
  v_lshlrev_b32 v52, 16, v49
  v_and_b32 v53, 0xffff0000, v49
  v_lshlrev_b32 v50, 16, v48
  v_and_b32 v51, 0xffff0000, v48
  v_mul_f32 v50, v50, v52
  v_mul_f32 v51, v51, v53
  v_cvt_pk_bf16_f32 v34, v50, v51
  v_pk_mul_f32 v[76:77], v[76:77], v[14:15] op_sel:[0,0] op_sel_hi:[1,0]
  v_pk_mul_f32 v[78:79], v[78:79], v[14:15] op_sel:[0,0] op_sel_hi:[1,0]
  v_cvt_pk_bf16_f32 v56, v76, v78
  v_cvt_pk_bf16_f32 v57, v77, v79
  v_pk_max_i16 v56, v56, 0
  v_lshlrev_b32 v60, 16, v57
  v_and_b32 v61, 0xffff0000, v57
  v_lshlrev_b32 v58, 16, v56
  v_and_b32 v59, 0xffff0000, v56
  v_mul_f32 v58, v58, v60
  v_mul_f32 v59, v59, v61
  v_cvt_pk_bf16_f32 v35, v58, v59
  v_permlane16_swap_b32 v32, v33
  s_nop 0
  v_permlane16_swap_b32 v34, v35
  s_nop 1
  v_permlane32_swap_b32 v32, v34
  v_permlane32_swap_b32 v33, v35
  buffer_store_dwordx4 v[32:35], v30, s[56:59], s14 offen sc1
  s_add_u32 s14, s14, 176128
  v_pk_mul_f32 v[80:81], v[80:81], v[16:17] op_sel:[0,0] op_sel_hi:[1,0]
  v_pk_mul_f32 v[82:83], v[82:83], v[16:17] op_sel:[0,0] op_sel_hi:[1,0]
  v_cvt_pk_bf16_f32 v48, v80, v82
  v_cvt_pk_bf16_f32 v49, v81, v83
  v_pk_max_i16 v48, v48, 0
  v_lshlrev_b32 v52, 16, v49
  v_and_b32 v53, 0xffff0000, v49
  v_lshlrev_b32 v50, 16, v48
  v_and_b32 v51, 0xffff0000, v48
  v_mul_f32 v50, v50, v52
  v_mul_f32 v51, v51, v53
  v_cvt_pk_bf16_f32 v36, v50, v51
  v_pk_mul_f32 v[84:85], v[84:85], v[18:19] op_sel:[0,0] op_sel_hi:[1,0]
  v_pk_mul_f32 v[86:87], v[86:87], v[18:19] op_sel:[0,0] op_sel_hi:[1,0]
  v_cvt_pk_bf16_f32 v56, v84, v86
  v_cvt_pk_bf16_f32 v57, v85, v87
  v_pk_max_i16 v56, v56, 0
  v_lshlrev_b32 v60, 16, v57
  v_and_b32 v61, 0xffff0000, v57
  v_lshlrev_b32 v58, 16, v56
  v_and_b32 v59, 0xffff0000, v56
  v_mul_f32 v58, v58, v60
  v_mul_f32 v59, v59, v61
  v_cvt_pk_bf16_f32 v37, v58, v59
  v_pk_mul_f32 v[88:89], v[88:89], v[20:21] op_sel:[0,0] op_sel_hi:[1,0]
  v_pk_mul_f32 v[90:91], v[90:91], v[20:21] op_sel:[0,0] op_sel_hi:[1,0]
  v_cvt_pk_bf16_f32 v48, v88, v90
  v_cvt_pk_bf16_f32 v49, v89, v91
  v_pk_max_i16 v48, v48, 0
  v_lshlrev_b32 v52, 16, v49
  v_and_b32 v53, 0xffff0000, v49
  v_lshlrev_b32 v50, 16, v48
  v_and_b32 v51, 0xffff0000, v48
  v_mul_f32 v50, v50, v52
  v_mul_f32 v51, v51, v53
  v_cvt_pk_bf16_f32 v38, v50, v51
  v_pk_mul_f32 v[92:93], v[92:93], v[22:23] op_sel:[0,0] op_sel_hi:[1,0]
  v_pk_mul_f32 v[94:95], v[94:95], v[22:23] op_sel:[0,0] op_sel_hi:[1,0]
  v_cvt_pk_bf16_f32 v56, v92, v94
  v_cvt_pk_bf16_f32 v57, v93, v95
  v_pk_max_i16 v56, v56, 0
  v_lshlrev_b32 v60, 16, v57
  v_and_b32 v61, 0xffff0000, v57
  v_lshlrev_b32 v58, 16, v56
  v_and_b32 v59, 0xffff0000, v56
  v_mul_f32 v58, v58, v60
  v_mul_f32 v59, v59, v61
  v_cvt_pk_bf16_f32 v39, v58, v59
  v_permlane16_swap_b32 v36, v37
  s_nop 0
  v_permlane16_swap_b32 v38, v39
  s_nop 1
  v_permlane32_swap_b32 v36, v38
  v_permlane32_swap_b32 v37, v39
  buffer_store_dwordx4 v[36:39], v30, s[56:59], s14 offen sc1
  s_mul_i32 s14, s6, 1376
  s_add_u32 s14, s14, s11
  s_lshl_b32 s14, s14, 8
  v_pk_mul_f32 v[96:97], v[96:97], v[8:9] op_sel:[0,0] op_sel_hi:[1,0]
  v_pk_mul_f32 v[98:99], v[98:99], v[8:9] op_sel:[0,0] op_sel_hi:[1,0]
  v_cvt_pk_bf16_f32 v48, v96, v98
  v_cvt_pk_bf16_f32 v49, v97, v99
  v_pk_max_i16 v48, v48, 0
  v_lshlrev_b32 v52, 16, v49
  v_and_b32 v53, 0xffff0000, v49
  v_lshlrev_b32 v50, 16, v48
  v_and_b32 v51, 0xffff0000, v48
  v_mul_f32 v50, v50, v52
  v_mul_f32 v51, v51, v53
  v_cvt_pk_bf16_f32 v40, v50, v51
  v_pk_mul_f32 v[100:101], v[100:101], v[10:11] op_sel:[0,0] op_sel_hi:[1,0]
  v_pk_mul_f32 v[102:103], v[102:103], v[10:11] op_sel:[0,0] op_sel_hi:[1,0]
  v_cvt_pk_bf16_f32 v56, v100, v102
  v_cvt_pk_bf16_f32 v57, v101, v103
  v_pk_max_i16 v56, v56, 0
  v_lshlrev_b32 v60, 16, v57
  v_and_b32 v61, 0xffff0000, v57
  v_lshlrev_b32 v58, 16, v56
  v_and_b32 v59, 0xffff0000, v56
  v_mul_f32 v58, v58, v60
  v_mul_f32 v59, v59, v61
  v_cvt_pk_bf16_f32 v41, v58, v59
  v_pk_mul_f32 v[104:105], v[104:105], v[12:13] op_sel:[0,0] op_sel_hi:[1,0]
  v_pk_mul_f32 v[106:107], v[106:107], v[12:13] op_sel:[0,0] op_sel_hi:[1,0]
  v_cvt_pk_bf16_f32 v48, v104, v106
  v_cvt_pk_bf16_f32 v49, v105, v107
  v_pk_max_i16 v48, v48, 0
  v_lshlrev_b32 v52, 16, v49
  v_and_b32 v53, 0xffff0000, v49
  v_lshlrev_b32 v50, 16, v48
  v_and_b32 v51, 0xffff0000, v48
  v_mul_f32 v50, v50, v52
  v_mul_f32 v51, v51, v53
  v_cvt_pk_bf16_f32 v42, v50, v51
  v_pk_mul_f32 v[108:109], v[108:109], v[14:15] op_sel:[0,0] op_sel_hi:[1,0]
  v_pk_mul_f32 v[110:111], v[110:111], v[14:15] op_sel:[0,0] op_sel_hi:[1,0]
  v_cvt_pk_bf16_f32 v56, v108, v110
  v_cvt_pk_bf16_f32 v57, v109, v111
  v_pk_max_i16 v56, v56, 0
  v_lshlrev_b32 v60, 16, v57
  v_and_b32 v61, 0xffff0000, v57
  v_lshlrev_b32 v58, 16, v56
  v_and_b32 v59, 0xffff0000, v56
  v_mul_f32 v58, v58, v60
  v_mul_f32 v59, v59, v61
  v_cvt_pk_bf16_f32 v43, v58, v59
  v_permlane16_swap_b32 v40, v41
  s_nop 0
  v_permlane16_swap_b32 v42, v43
  s_nop 1
  v_permlane32_swap_b32 v40, v42
  v_permlane32_swap_b32 v41, v43
  buffer_store_dwordx4 v[40:43], v30, s[56:59], s14 offen sc1
  s_add_u32 s14, s14, 176128
  v_pk_mul_f32 v[112:113], v[112:113], v[16:17] op_sel:[0,0] op_sel_hi:[1,0]
  v_pk_mul_f32 v[114:115], v[114:115], v[16:17] op_sel:[0,0] op_sel_hi:[1,0]
  v_cvt_pk_bf16_f32 v48, v112, v114
  v_cvt_pk_bf16_f32 v49, v113, v115
  v_pk_max_i16 v48, v48, 0
  v_lshlrev_b32 v52, 16, v49
  v_and_b32 v53, 0xffff0000, v49
  v_lshlrev_b32 v50, 16, v48
  v_and_b32 v51, 0xffff0000, v48
  v_mul_f32 v50, v50, v52
  v_mul_f32 v51, v51, v53
  v_cvt_pk_bf16_f32 v44, v50, v51
  v_pk_mul_f32 v[116:117], v[116:117], v[18:19] op_sel:[0,0] op_sel_hi:[1,0]
  v_pk_mul_f32 v[118:119], v[118:119], v[18:19] op_sel:[0,0] op_sel_hi:[1,0]
  v_cvt_pk_bf16_f32 v56, v116, v118
  v_cvt_pk_bf16_f32 v57, v117, v119
  v_pk_max_i16 v56, v56, 0
  v_lshlrev_b32 v60, 16, v57
  v_and_b32 v61, 0xffff0000, v57
  v_lshlrev_b32 v58, 16, v56
  v_and_b32 v59, 0xffff0000, v56
  v_mul_f32 v58, v58, v60
  v_mul_f32 v59, v59, v61
  v_cvt_pk_bf16_f32 v45, v58, v59
  v_pk_mul_f32 v[120:121], v[120:121], v[20:21] op_sel:[0,0] op_sel_hi:[1,0]
  v_pk_mul_f32 v[122:123], v[122:123], v[20:21] op_sel:[0,0] op_sel_hi:[1,0]
  v_cvt_pk_bf16_f32 v48, v120, v122
  v_cvt_pk_bf16_f32 v49, v121, v123
  v_pk_max_i16 v48, v48, 0
  v_lshlrev_b32 v52, 16, v49
  v_and_b32 v53, 0xffff0000, v49
  v_lshlrev_b32 v50, 16, v48
  v_and_b32 v51, 0xffff0000, v48
  v_mul_f32 v50, v50, v52
  v_mul_f32 v51, v51, v53
  v_cvt_pk_bf16_f32 v46, v50, v51
  v_pk_mul_f32 v[124:125], v[124:125], v[22:23] op_sel:[0,0] op_sel_hi:[1,0]
  v_pk_mul_f32 v[126:127], v[126:127], v[22:23] op_sel:[0,0] op_sel_hi:[1,0]
  v_cvt_pk_bf16_f32 v56, v124, v126
  v_cvt_pk_bf16_f32 v57, v125, v127
  v_pk_max_i16 v56, v56, 0
  v_lshlrev_b32 v60, 16, v57
  v_and_b32 v61, 0xffff0000, v57
  v_lshlrev_b32 v58, 16, v56
  v_and_b32 v59, 0xffff0000, v56
  v_mul_f32 v58, v58, v60
  v_mul_f32 v59, v59, v61
  v_cvt_pk_bf16_f32 v47, v58, v59
  v_permlane16_swap_b32 v44, v45
  s_nop 0
  v_permlane16_swap_b32 v46, v47
  s_nop 1
  v_permlane32_swap_b32 v44, v46
  v_permlane32_swap_b32 v45, v47
  buffer_store_dwordx4 v[44:47], v30, s[56:59], s14 offen sc1
G1_DONE:
  s_lshl_b32 s12, s6, 11
  s_waitcnt vmcnt(0)
  s_barrier
  s_cmp_lg_u32 s3, 5
  s_cbranch_scc1 SIG_C
  v_mov_b32 v6, 0
  s_add_u32 s14, s25, 4
  s_add_u32 s14, s14, s27
  v_mov_b32 v5, s14
  s_mov_b64 exec, 1
  buffer_store_dword v5, v6, s[76:79], s24 offen sc0 sc1
  s_mov_b64 exec, -1
SIG_C:
  s_add_u32 s48, s42, 0x00e00000
  s_addc_u32 s49, s43, 0
  s_and_b32 s49, s49, 0xffff
  s_mov_b32 s50, 0x00560000
  s_mov_b32 s51, 0x00020000
  s_mov_b32 s56, s38
  s_and_b32 s57, s39, 0xffff
  s_mov_b32 s58, 0x00200000
  s_mov_b32 s59, 0x00020000
  s_cmp_lg_u32 s3, 5
  s_cbranch_scc1 WT_C
  v_lshlrev_b32 v5, 7, v1
  s_add_u32 s14, s25, 4
  s_mov_b64 exec, 0x0000ffff
  s_mov_b32 s15, 0x40000
WL_C:
  buffer_load_dword v16, v5, s[76:79], s12 offen sc1
  s_waitcnt vmcnt(0)
  v_mov_b32 v17, v16
  v_mov_b32 v18, v16
  v_mov_b32 v19, v16
  s_waitcnt vmcnt(0)
  v_subrev_u32 v16, s25, v16
  v_subrev_u32 v17, s25, v17
  v_subrev_u32 v18, s25, v18
  v_subrev_u32 v19, s25, v19
  v_and_b32 v52, 0xffffffc7, v16
  v_and_b32 v53, 0xffffffc7, v17
  v_and_b32 v54, 0xffffffc7, v18
  v_and_b32 v55, 0xffffffc7, v19
  v_subrev_u32 v52, 4, v52
  v_subrev_u32 v53, 4, v53
  v_subrev_u32 v54, 4, v54
  v_subrev_u32 v55, 4, v55
  v_max3_u32 v52, v52, v53, v54
  v_max_u32 v52, v52, v55
  v_cmp_lt_u32 vcc, 0, v52
  s_sub_u32 s15, s15, 1
  s_cmp_eq_u32 s15, 0
  s_cbranch_scc1 WD_C
  s_and_b64 vcc, vcc, exec
  s_cbranch_vccz WD_C
  s_sleep 4
  s_branch WL_C
WD_C:
  s_mov_b64 exec, -1
WT_C:
  v_lshlrev_b32 v3, 4, v1
  v_lshl_add_u32 v7, v2, 14, v3
  s_barrier
  s_cmp_ge_u32 s3, 3
  s_cbranch_scc1 G2_FIVE
  buffer_load_dwordx4 v[48:51], v3, s[48:51], s64 offen sc1
  buffer_load_dwordx4 v[52:55], v3, s[48:51], s65 offen sc1
  buffer_load_dwordx4 v[56:59], v3, s[48:51], s66 offen sc1
  buffer_load_dwordx4 v[60:63], v3, s[48:51], s67 offen sc1
  s_add_u32 s64, s64, 8192
  s_add_u32 s65, s65, 8192
  s_add_u32 s66, s66, 8192
  s_add_u32 s67, s67, 8192
  buffer_load_dwordx4 v[64:67], v3, s[48:51], s64 offen sc1
  buffer_load_dwordx4 v[68:71], v3, s[48:51], s65 offen sc1
  buffer_load_dwordx4 v[72:75], v3, s[48:51], s66 offen sc1
  buffer_load_dwordx4 v[76:79], v3, s[48:51], s67 offen sc1
  s_add_u32 s64, s64, 8192
  s_add_u32 s65, s65, 8192
  s_add_u32 s66, s66, 8192
  s_add_u32 s67, s67, 8192
  buffer_load_dwordx4 v[80:83], v3, s[48:51], s64 offen sc1
  buffer_load_dwordx4 v[84:87], v3, s[48:51], s65 offen sc1
  buffer_load_dwordx4 v[88:91], v3, s[48:51], s66 offen sc1
  buffer_load_dwordx4 v[92:95], v3, s[48:51], s67 offen sc1
  s_add_u32 s64, s64, 8192
  s_add_u32 s65, s65, 8192
  s_add_u32 s66, s66, 8192
  s_add_u32 s67, s67, 8192
  buffer_load_dwordx4 v[96:99], v3, s[48:51], s64 offen sc1
  buffer_load_dwordx4 v[100:103], v3, s[48:51], s65 offen sc1
  buffer_load_dwordx4 v[104:107], v3, s[48:51], s66 offen sc1
  buffer_load_dwordx4 v[108:111], v3, s[48:51], s67 offen sc1
  s_add_u32 s64, s64, 8192
  s_add_u32 s65, s65, 8192
  s_add_u32 s66, s66, 8192
  s_add_u32 s67, s67, 8192
  buffer_load_dwordx4 v[112:115], v3, s[48:51], s64 offen sc1
  buffer_load_dwordx4 v[116:119], v3, s[48:51], s65 offen sc1
  buffer_load_dwordx4 v[120:123], v3, s[48:51], s66 offen sc1
  buffer_load_dwordx4 v[124:127], v3, s[48:51], s67 offen sc1
  s_add_u32 s64, s64, 8192
  s_add_u32 s65, s65, 8192
  s_add_u32 s66, s66, 8192
  s_add_u32 s67, s67, 8192
  s_waitcnt vmcnt(16)
  v_mfma_f32_16x16x32_bf16 a[96:99], a[0:3], v[48:51], 0
  v_mfma_f32_16x16x32_bf16 a[100:103], a[0:3], v[52:55], 0
  v_mfma_f32_16x16x32_bf16 a[104:107], a[0:3], v[56:59], 0
  v_mfma_f32_16x16x32_bf16 a[108:111], a[0:3], v[60:63], 0
  v_mfma_f32_16x16x32_bf16 a[112:115], a[4:7], v[48:51], 0
  v_mfma_f32_16x16x32_bf16 a[116:119], a[4:7], v[52:55], 0
  v_mfma_f32_16x16x32_bf16 a[120:123], a[4:7], v[56:59], 0
  v_mfma_f32_16x16x32_bf16 a[124:127], a[4:7], v[60:63], 0
  v_mfma_f32_16x16x32_bf16 v[16:19], a[8:11], v[48:51], 0
  v_mfma_f32_16x16x32_bf16 v[20:23], a[8:11], v[52:55], 0
  v_mfma_f32_16x16x32_bf16 v[24:27], a[8:11], v[56:59], 0
  v_mfma_f32_16x16x32_bf16 v[28:31], a[8:11], v[60:63], 0
  v_mfma_f32_16x16x32_bf16 v[32:35], a[12:15], v[48:51], 0
  v_mfma_f32_16x16x32_bf16 v[36:39], a[12:15], v[52:55], 0
  v_mfma_f32_16x16x32_bf16 v[40:43], a[12:15], v[56:59], 0
  v_mfma_f32_16x16x32_bf16 v[44:47], a[12:15], v[60:63], 0
  buffer_load_dwordx4 v[48:51], v3, s[48:51], s64 offen sc1
  buffer_load_dwordx4 v[52:55], v3, s[48:51], s65 offen sc1
  buffer_load_dwordx4 v[56:59], v3, s[48:51], s66 offen sc1
  buffer_load_dwordx4 v[60:63], v3, s[48:51], s67 offen sc1
  s_add_u32 s64, s64, 8192
  s_add_u32 s65, s65, 8192
  s_add_u32 s66, s66, 8192
  s_add_u32 s67, s67, 8192
  s_waitcnt vmcnt(16)
  v_mfma_f32_16x16x32_bf16 a[96:99], a[64:67], v[64:67], a[96:99]
  v_mfma_f32_16x16x32_bf16 a[100:103], a[64:67], v[68:71], a[100:103]
  v_mfma_f32_16x16x32_bf16 a[104:107], a[64:67], v[72:75], a[104:107]
  v_mfma_f32_16x16x32_bf16 a[108:111], a[64:67], v[76:79], a[108:111]
  v_mfma_f32_16x16x32_bf16 a[112:115], a[68:71], v[64:67], a[112:115]
  v_mfma_f32_16x16x32_bf16 a[116:119], a[68:71], v[68:71], a[116:119]
  v_mfma_f32_16x16x32_bf16 a[120:123], a[68:71], v[72:75], a[120:123]
  v_mfma_f32_16x16x32_bf16 a[124:127], a[68:71], v[76:79], a[124:127]
  v_mfma_f32_16x16x32_bf16 v[16:19], a[72:75], v[64:67], v[16:19]
  v_mfma_f32_16x16x32_bf16 v[20:23], a[72:75], v[68:71], v[20:23]
  v_mfma_f32_16x16x32_bf16 v[24:27], a[72:75], v[72:75], v[24:27]
  v_mfma_f32_16x16x32_bf16 v[28:31], a[72:75], v[76:79], v[28:31]
  v_mfma_f32_16x16x32_bf16 v[32:35], a[76:79], v[64:67], v[32:35]
  v_mfma_f32_16x16x32_bf16 v[36:39], a[76:79], v[68:71], v[36:39]
  v_mfma_f32_16x16x32_bf16 v[40:43], a[76:79], v[72:75], v[40:43]
  v_mfma_f32_16x16x32_bf16 v[44:47], a[76:79], v[76:79], v[44:47]
  s_waitcnt vmcnt(12)
  v_mfma_f32_16x16x32_bf16 a[96:99], a[16:19], v[80:83], a[96:99]
  v_mfma_f32_16x16x32_bf16 a[100:103], a[16:19], v[84:87], a[100:103]
  v_mfma_f32_16x16x32_bf16 a[104:107], a[16:19], v[88:91], a[104:107]
  v_mfma_f32_16x16x32_bf16 a[108:111], a[16:19], v[92:95], a[108:111]
  v_mfma_f32_16x16x32_bf16 a[112:115], a[20:23], v[80:83], a[112:115]
  v_mfma_f32_16x16x32_bf16 a[116:119], a[20:23], v[84:87], a[116:119]
  v_mfma_f32_16x16x32_bf16 a[120:123], a[20:23], v[88:91], a[120:123]
  v_mfma_f32_16x16x32_bf16 a[124:127], a[20:23], v[92:95], a[124:127]
  v_mfma_f32_16x16x32_bf16 v[16:19], a[24:27], v[80:83], v[16:19]
  v_mfma_f32_16x16x32_bf16 v[20:23], a[24:27], v[84:87], v[20:23]
  v_mfma_f32_16x16x32_bf16 v[24:27], a[24:27], v[88:91], v[24:27]
  v_mfma_f32_16x16x32_bf16 v[28:31], a[24:27], v[92:95], v[28:31]
  v_mfma_f32_16x16x32_bf16 v[32:35], a[28:31], v[80:83], v[32:35]
  v_mfma_f32_16x16x32_bf16 v[36:39], a[28:31], v[84:87], v[36:39]
  v_mfma_f32_16x16x32_bf16 v[40:43], a[28:31], v[88:91], v[40:43]
  v_mfma_f32_16x16x32_bf16 v[44:47], a[28:31], v[92:95], v[44:47]
  s_waitcnt vmcnt(8)
  v_mfma_f32_16x16x32_bf16 a[96:99], a[80:83], v[96:99], a[96:99]
  v_mfma_f32_16x16x32_bf16 a[100:103], a[80:83], v[100:103], a[100:103]
  v_mfma_f32_16x16x32_bf16 a[104:107], a[80:83], v[104:107], a[104:107]
  v_mfma_f32_16x16x32_bf16 a[108:111], a[80:83], v[108:111], a[108:111]
  v_mfma_f32_16x16x32_bf16 a[112:115], a[84:87], v[96:99], a[112:115]
  v_mfma_f32_16x16x32_bf16 a[116:119], a[84:87], v[100:103], a[116:119]
  v_mfma_f32_16x16x32_bf16 a[120:123], a[84:87], v[104:107], a[120:123]
  v_mfma_f32_16x16x32_bf16 a[124:127], a[84:87], v[108:111], a[124:127]
  v_mfma_f32_16x16x32_bf16 v[16:19], a[88:91], v[96:99], v[16:19]
  v_mfma_f32_16x16x32_bf16 v[20:23], a[88:91], v[100:103], v[20:23]
  v_mfma_f32_16x16x32_bf16 v[24:27], a[88:91], v[104:107], v[24:27]
  v_mfma_f32_16x16x32_bf16 v[28:31], a[88:91], v[108:111], v[28:31]
  v_mfma_f32_16x16x32_bf16 v[32:35], a[92:95], v[96:99], v[32:35]
  v_mfma_f32_16x16x32_bf16 v[36:39], a[92:95], v[100:103], v[36:39]
  v_mfma_f32_16x16x32_bf16 v[40:43], a[92:95], v[104:107], v[40:43]
  v_mfma_f32_16x16x32_bf16 v[44:47], a[92:95], v[108:111], v[44:47]
  s_waitcnt vmcnt(4)
  v_mfma_f32_16x16x32_bf16 a[96:99], a[32:35], v[112:115], a[96:99]
  v_mfma_f32_16x16x32_bf16 a[100:103], a[32:35], v[116:119], a[100:103]
  v_mfma_f32_16x16x32_bf16 a[104:107], a[32:35], v[120:123], a[104:107]
  v_mfma_f32_16x16x32_bf16 a[108:111], a[32:35], v[124:127], a[108:111]
  v_mfma_f32_16x16x32_bf16 a[112:115], a[36:39], v[112:115], a[112:115]
  v_mfma_f32_16x16x32_bf16 a[116:119], a[36:39], v[116:119], a[116:119]
  v_mfma_f32_16x16x32_bf16 a[120:123], a[36:39], v[120:123], a[120:123]
  v_mfma_f32_16x16x32_bf16 a[124:127], a[36:39], v[124:127], a[124:127]
  v_mfma_f32_16x16x32_bf16 v[16:19], a[40:43], v[112:115], v[16:19]
  v_mfma_f32_16x16x32_bf16 v[20:23], a[40:43], v[116:119], v[20:23]
  v_mfma_f32_16x16x32_bf16 v[24:27], a[40:43], v[120:123], v[24:27]
  v_mfma_f32_16x16x32_bf16 v[28:31], a[40:43], v[124:127], v[28:31]
  v_mfma_f32_16x16x32_bf16 v[32:35], a[44:47], v[112:115], v[32:35]
  v_mfma_f32_16x16x32_bf16 v[36:39], a[44:47], v[116:119], v[36:39]
  v_mfma_f32_16x16x32_bf16 v[40:43], a[44:47], v[120:123], v[40:43]
  v_mfma_f32_16x16x32_bf16 v[44:47], a[44:47], v[124:127], v[44:47]
  s_waitcnt vmcnt(0)
  v_mfma_f32_16x16x32_bf16 a[96:99], a[48:51], v[48:51], a[96:99]
  v_mfma_f32_16x16x32_bf16 a[100:103], a[48:51], v[52:55], a[100:103]
  v_mfma_f32_16x16x32_bf16 a[104:107], a[48:51], v[56:59], a[104:107]
  v_mfma_f32_16x16x32_bf16 a[108:111], a[48:51], v[60:63], a[108:111]
  v_mfma_f32_16x16x32_bf16 a[112:115], a[52:55], v[48:51], a[112:115]
  v_mfma_f32_16x16x32_bf16 a[116:119], a[52:55], v[52:55], a[116:119]
  v_mfma_f32_16x16x32_bf16 a[120:123], a[52:55], v[56:59], a[120:123]
  s_nop 1
  ds_write_b128 v7, a[96:99] offset:0
  v_mfma_f32_16x16x32_bf16 a[124:127], a[52:55], v[60:63], a[124:127]
  ds_write_b128 v7, a[100:103] offset:1024
  v_mfma_f32_16x16x32_bf16 v[16:19], a[56:59], v[48:51], v[16:19]
  ds_write_b128 v7, a[104:107] offset:2048
  v_mfma_f32_16x16x32_bf16 v[20:23], a[56:59], v[52:55], v[20:23]
  ds_write_b128 v7, a[108:111] offset:3072
  v_mfma_f32_16x16x32_bf16 v[24:27], a[56:59], v[56:59], v[24:27]
  ds_write_b128 v7, a[112:115] offset:4096
  v_mfma_f32_16x16x32_bf16 v[28:31], a[56:59], v[60:63], v[28:31]
  ds_write_b128 v7, a[116:119] offset:5120
  v_mfma_f32_16x16x32_bf16 v[32:35], a[60:63], v[48:51], v[32:35]
  ds_write_b128 v7, a[120:123] offset:6144
  v_mfma_f32_16x16x32_bf16 v[36:39], a[60:63], v[52:55], v[36:39]
  ds_write_b128 v7, a[124:127] offset:7168
  v_mfma_f32_16x16x32_bf16 v[40:43], a[60:63], v[56:59], v[40:43]
  ds_write_b128 v7, v[16:19] offset:8192
  v_mfma_f32_16x16x32_bf16 v[44:47], a[60:63], v[60:63], v[44:47]
  ds_write_b128 v7, v[20:23] offset:9216
  s_branch G2_RED
G2_FIVE:
  buffer_load_dwordx4 v[48:51], v3, s[48:51], s64 offen sc1
  buffer_load_dwordx4 v[52:55], v3, s[48:51], s65 offen sc1
  buffer_load_dwordx4 v[56:59], v3, s[48:51], s66 offen sc1
  buffer_load_dwordx4 v[60:63], v3, s[48:51], s67 offen sc1
  s_add_u32 s64, s64, 8192
  s_add_u32 s65, s65, 8192
  s_add_u32 s66, s66, 8192
  s_add_u32 s67, s67, 8192
  buffer_load_dwordx4 v[64:67], v3, s[48:51], s64 offen sc1
  buffer_load_dwordx4 v[68:71], v3, s[48:51], s65 offen sc1
  buffer_load_dwordx4 v[72:75], v3, s[48:51], s66 offen sc1
  buffer_load_dwordx4 v[76:79], v3, s[48:51], s67 offen sc1
  s_add_u32 s64, s64, 8192
  s_add_u32 s65, s65, 8192
  s_add_u32 s66, s66, 8192
  s_add_u32 s67, s67, 8192
  buffer_load_dwordx4 v[80:83], v3, s[48:51], s64 offen sc1
  buffer_load_dwordx4 v[84:87], v3, s[48:51], s65 offen sc1
  buffer_load_dwordx4 v[88:91], v3, s[48:51], s66 offen sc1
  buffer_load_dwordx4 v[92:95], v3, s[48:51], s67 offen sc1
  s_add_u32 s64, s64, 8192
  s_add_u32 s65, s65, 8192
  s_add_u32 s66, s66, 8192
  s_add_u32 s67, s67, 8192
  buffer_load_dwordx4 v[96:99], v3, s[48:51], s64 offen sc1
  buffer_load_dwordx4 v[100:103], v3, s[48:51], s65 offen sc1
  buffer_load_dwordx4 v[104:107], v3, s[48:51], s66 offen sc1
  buffer_load_dwordx4 v[108:111], v3, s[48:51], s67 offen sc1
  s_add_u32 s64, s64, 8192
  s_add_u32 s65, s65, 8192
  s_add_u32 s66, s66, 8192
  s_add_u32 s67, s67, 8192
  buffer_load_dwordx4 v[112:115], v3, s[48:51], s64 offen sc1
  buffer_load_dwordx4 v[116:119], v3, s[48:51], s65 offen sc1
  buffer_load_dwordx4 v[120:123], v3, s[48:51], s66 offen sc1
  buffer_load_dwordx4 v[124:127], v3, s[48:51], s67 offen sc1
  s_add_u32 s64, s64, 8192
  s_add_u32 s65, s65, 8192
  s_add_u32 s66, s66, 8192
  s_add_u32 s67, s67, 8192
  s_waitcnt vmcnt(16)
  v_mfma_f32_16x16x32_bf16 a[96:99], a[0:3], v[48:51], 0
  v_mfma_f32_16x16x32_bf16 a[100:103], a[0:3], v[52:55], 0
  v_mfma_f32_16x16x32_bf16 a[104:107], a[0:3], v[56:59], 0
  v_mfma_f32_16x16x32_bf16 a[108:111], a[0:3], v[60:63], 0
  v_mfma_f32_16x16x32_bf16 a[112:115], a[4:7], v[48:51], 0
  v_mfma_f32_16x16x32_bf16 a[116:119], a[4:7], v[52:55], 0
  v_mfma_f32_16x16x32_bf16 a[120:123], a[4:7], v[56:59], 0
  v_mfma_f32_16x16x32_bf16 a[124:127], a[4:7], v[60:63], 0
  v_mfma_f32_16x16x32_bf16 v[16:19], a[8:11], v[48:51], 0
  v_mfma_f32_16x16x32_bf16 v[20:23], a[8:11], v[52:55], 0
  v_mfma_f32_16x16x32_bf16 v[24:27], a[8:11], v[56:59], 0
  v_mfma_f32_16x16x32_bf16 v[28:31], a[8:11], v[60:63], 0
  v_mfma_f32_16x16x32_bf16 v[32:35], a[12:15], v[48:51], 0
  v_mfma_f32_16x16x32_bf16 v[36:39], a[12:15], v[52:55], 0
  v_mfma_f32_16x16x32_bf16 v[40:43], a[12:15], v[56:59], 0
  v_mfma_f32_16x16x32_bf16 v[44:47], a[12:15], v[60:63], 0
  s_waitcnt vmcnt(12)
  v_mfma_f32_16x16x32_bf16 a[96:99], a[64:67], v[64:67], a[96:99]
  v_mfma_f32_16x16x32_bf16 a[100:103], a[64:67], v[68:71], a[100:103]
  v_mfma_f32_16x16x32_bf16 a[104:107], a[64:67], v[72:75], a[104:107]
  v_mfma_f32_16x16x32_bf16 a[108:111], a[64:67], v[76:79], a[108:111]
  v_mfma_f32_16x16x32_bf16 a[112:115], a[68:71], v[64:67], a[112:115]
  v_mfma_f32_16x16x32_bf16 a[116:119], a[68:71], v[68:71], a[116:119]
  v_mfma_f32_16x16x32_bf16 a[120:123], a[68:71], v[72:75], a[120:123]
  v_mfma_f32_16x16x32_bf16 a[124:127], a[68:71], v[76:79], a[124:127]
  v_mfma_f32_16x16x32_bf16 v[16:19], a[72:75], v[64:67], v[16:19]
  v_mfma_f32_16x16x32_bf16 v[20:23], a[72:75], v[68:71], v[20:23]
  v_mfma_f32_16x16x32_bf16 v[24:27], a[72:75], v[72:75], v[24:27]
  v_mfma_f32_16x16x32_bf16 v[28:31], a[72:75], v[76:79], v[28:31]
  v_mfma_f32_16x16x32_bf16 v[32:35], a[76:79], v[64:67], v[32:35]
  v_mfma_f32_16x16x32_bf16 v[36:39], a[76:79], v[68:71], v[36:39]
  v_mfma_f32_16x16x32_bf16 v[40:43], a[76:79], v[72:75], v[40:43]
  v_mfma_f32_16x16x32_bf16 v[44:47], a[76:79], v[76:79], v[44:47]
  s_waitcnt vmcnt(8)
  v_mfma_f32_16x16x32_bf16 a[96:99], a[16:19], v[80:83], a[96:99]
  v_mfma_f32_16x16x32_bf16 a[100:103], a[16:19], v[84:87], a[100:103]
  v_mfma_f32_16x16x32_bf16 a[104:107], a[16:19], v[88:91], a[104:107]
  v_mfma_f32_16x16x32_bf16 a[108:111], a[16:19], v[92:95], a[108:111]
  v_mfma_f32_16x16x32_bf16 a[112:115], a[20:23], v[80:83], a[112:115]
  v_mfma_f32_16x16x32_bf16 a[116:119], a[20:23], v[84:87], a[116:119]
  v_mfma_f32_16x16x32_bf16 a[120:123], a[20:23], v[88:91], a[120:123]
  v_mfma_f32_16x16x32_bf16 a[124:127], a[20:23], v[92:95], a[124:127]
  v_mfma_f32_16x16x32_bf16 v[16:19], a[24:27], v[80:83], v[16:19]
  v_mfma_f32_16x16x32_bf16 v[20:23], a[24:27], v[84:87], v[20:23]
  v_mfma_f32_16x16x32_bf16 v[24:27], a[24:27], v[88:91], v[24:27]
  v_mfma_f32_16x16x32_bf16 v[28:31], a[24:27], v[92:95], v[28:31]
  v_mfma_f32_16x16x32_bf16 v[32:35], a[28:31], v[80:83], v[32:35]
  v_mfma_f32_16x16x32_bf16 v[36:39], a[28:31], v[84:87], v[36:39]
  v_mfma_f32_16x16x32_bf16 v[40:43], a[28:31], v[88:91], v[40:43]
  v_mfma_f32_16x16x32_bf16 v[44:47], a[28:31], v[92:95], v[44:47]
  s_waitcnt vmcnt(4)
  v_mfma_f32_16x16x32_bf16 a[96:99], a[80:83], v[96:99], a[96:99]
  v_mfma_f32_16x16x32_bf16 a[100:103], a[80:83], v[100:103], a[100:103]
  v_mfma_f32_16x16x32_bf16 a[104:107], a[80:83], v[104:107], a[104:107]
  v_mfma_f32_16x16x32_bf16 a[108:111], a[80:83], v[108:111], a[108:111]
  v_mfma_f32_16x16x32_bf16 a[112:115], a[84:87], v[96:99], a[112:115]
  v_mfma_f32_16x16x32_bf16 a[116:119], a[84:87], v[100:103], a[116:119]
  v_mfma_f32_16x16x32_bf16 a[120:123], a[84:87], v[104:107], a[120:123]
  v_mfma_f32_16x16x32_bf16 a[124:127], a[84:87], v[108:111], a[124:127]
  v_mfma_f32_16x16x32_bf16 v[16:19], a[88:91], v[96:99], v[16:19]
  v_mfma_f32_16x16x32_bf16 v[20:23], a[88:91], v[100:103], v[20:23]
  v_mfma_f32_16x16x32_bf16 v[24:27], a[88:91], v[104:107], v[24:27]
  v_mfma_f32_16x16x32_bf16 v[28:31], a[88:91], v[108:111], v[28:31]
  v_mfma_f32_16x16x32_bf16 v[32:35], a[92:95], v[96:99], v[32:35]
  v_mfma_f32_16x16x32_bf16 v[36:39], a[92:95], v[100:103], v[36:39]
  v_mfma_f32_16x16x32_bf16 v[40:43], a[92:95], v[104:107], v[40:43]
  v_mfma_f32_16x16x32_bf16 v[44:47], a[92:95], v[108:111], v[44:47]
  s_waitcnt vmcnt(0)
  v_mfma_f32_16x16x32_bf16 a[96:99], a[32:35], v[112:115], a[96:99]
  v_mfma_f32_16x16x32_bf16 a[100:103], a[32:35], v[116:119], a[100:103]
  v_mfma_f32_16x16x32_bf16 a[104:107], a[32:35], v[120:123], a[104:107]
  v_mfma_f32_16x16x32_bf16 a[108:111], a[32:35], v[124:127], a[108:111]
  v_mfma_f32_16x16x32_bf16 a[112:115], a[36:39], v[112:115], a[112:115]
  v_mfma_f32_16x16x32_bf16 a[116:119], a[36:39], v[116:119], a[116:119]
  v_mfma_f32_16x16x32_bf16 a[120:123], a[36:39], v[120:123], a[120:123]
  s_nop 1
  ds_write_b128 v7, a[96:99] offset:0
  v_mfma_f32_16x16x32_bf16 a[124:127], a[36:39], v[124:127], a[124:127]
  ds_write_b128 v7, a[100:103] offset:1024
  v_mfma_f32_16x16x32_bf16 v[16:19], a[40:43], v[112:115], v[16:19]
  ds_write_b128 v7, a[104:107] offset:2048
  v_mfma_f32_16x16x32_bf16 v[20:23], a[40:43], v[116:119], v[20:23]
  ds_write_b128 v7, a[108:111] offset:3072
  v_mfma_f32_16x16x32_bf16 v[24:27], a[40:43], v[120:123], v[24:27]
  ds_write_b128 v7, a[112:115] offset:4096
  v_mfma_f32_16x16x32_bf16 v[28:31], a[40:43], v[124:127], v[28:31]
  ds_write_b128 v7, a[116:119] offset:5120
  v_mfma_f32_16x16x32_bf16 v[32:35], a[44:47], v[112:115], v[32:35]
  ds_write_b128 v7, a[120:123] offset:6144
  v_mfma_f32_16x16x32_bf16 v[36:39], a[44:47], v[116:119], v[36:39]
  ds_write_b128 v7, a[124:127] offset:7168
  v_mfma_f32_16x16x32_bf16 v[40:43], a[44:47], v[120:123], v[40:43]
  ds_write_b128 v7, v[16:19] offset:8192
  v_mfma_f32_16x16x32_bf16 v[44:47], a[44:47], v[124:127], v[44:47]
  ds_write_b128 v7, v[20:23] offset:9216
  s_branch G2_RED
G2_RED:
  v_and_b32 v4, 15, v1
  v_lshrrev_b32 v5, 4, v1
  v_lshlrev_b32 v6, 10, v4
  v_lshl_add_u32 v6, v5, 3, v6
  s_lshl_b32 s8, s5, 16
  s_lshl_b32 s9, s4, 7
  s_add_u32 s8, s8, s9
  s_lshr_b32 s9, s3, 1
  s_lshl_b32 s9, s9, 5
  s_add_u32 s8, s8, s9
  s_and_b32 s13, s3, 1
  s_lshl_b32 s14, s13, 15
  s_add_u32 s60, s8, s14
  s_add_u32 s61, s60, 16384
  v_mul_u32_u24 v8, 144, v4
  v_lshl_add_u32 v8, v5, 3, v8
  s_mul_i32 s14, s13, 4608
  s_add_u32 s14, s14, s9
  s_add_u32 s14, s14, 148992
  v_add_u32 v8, s14, v8
  ds_read_b64 v[10:11], v8
  ds_read_b64 v[12:13], v8 offset:2304
  s_nop 7
  ds_write_b128 v7, v[24:27] offset:10240
  ds_write_b128 v7, v[28:31] offset:11264
  ds_write_b128 v7, v[32:35] offset:12288
  ds_write_b128 v7, v[36:39] offset:13312
  ds_write_b128 v7, v[40:43] offset:14336
  ds_write_b128 v7, v[44:47] offset:15360
  v_lshl_add_u32 v7, v2, 11, v3
  v_add_u32 v9, 65536, v7
  s_waitcnt lgkmcnt(0)
  s_barrier
  ds_read_b128 v[64:67], v7 offset:0
  ds_read_b128 v[68:71], v7 offset:16384
  ds_read_b128 v[72:75], v7 offset:32768
  ds_read_b128 v[76:79], v7 offset:49152
  ds_read_b128 v[80:83], v9 offset:0
  ds_read_b128 v[84:87], v9 offset:16384
  ds_read_b128 v[88:91], v9 offset:32768
  ds_read_b128 v[92:95], v9 offset:49152
  ds_read_b128 v[96:99], v7 offset:1024
  ds_read_b128 v[100:103], v7 offset:17408
  ds_read_b128 v[104:107], v7 offset:33792
  ds_read_b128 v[108:111], v7 offset:50176
  ds_read_b128 v[112:115], v9 offset:1024
  ds_read_b128 v[116:119], v9 offset:17408
  ds_read_b128 v[120:123], v9 offset:33792
  ds_read_b128 v[124:127], v9 offset:50176
  s_waitcnt lgkmcnt(0)
  v_add_f32 v64, v64, v80
  v_add_f32 v65, v65, v81
  v_add_f32 v66, v66, v82
  v_add_f32 v67, v67, v83
  v_add_f32 v68, v68, v84
  v_add_f32 v69, v69, v85
  v_add_f32 v70, v70, v86
  v_add_f32 v71, v71, v87
  v_add_f32 v72, v72, v88
  v_add_f32 v73, v73, v89
  v_add_f32 v74, v74, v90
  v_add_f32 v75, v75, v91
  v_add_f32 v76, v76, v92
  v_add_f32 v77, v77, v93
  v_add_f32 v78, v78, v94
  v_add_f32 v79, v79, v95
  v_add_f32 v64, v64, v72
  v_add_f32 v65, v65, v73
  v_add_f32 v66, v66, v74
  v_add_f32 v67, v67, v75
  v_add_f32 v68, v68, v76
  v_add_f32 v69, v69, v77
  v_add_f32 v70, v70, v78
  v_add_f32 v71, v71, v79
  v_add_f32 v64, v64, v68
  v_add_f32 v65, v65, v69
  v_add_f32 v66, v66, v70
  v_add_f32 v67, v67, v71
  v_cvt_pk_bf16_f32 v68, v64, v65
  v_cvt_pk_bf16_f32 v69, v66, v67
  v_lshlrev_b32 v64, 16, v68
  v_and_b32 v65, 0xffff0000, v68
  v_lshlrev_b32 v72, 16, v10
  v_and_b32 v73, 0xffff0000, v10
  v_lshlrev_b32 v66, 16, v69
  v_and_b32 v67, 0xffff0000, v69
  v_lshlrev_b32 v74, 16, v11
  v_and_b32 v75, 0xffff0000, v11
  v_add_f32 v64, v64, v72
  v_add_f32 v65, v65, v73
  v_add_f32 v66, v66, v74
  v_add_f32 v67, v67, v75
  v_cvt_pk_bf16_f32 v68, v64, v65
  v_cvt_pk_bf16_f32 v69, v66, v67
  buffer_store_dwordx2 v[68:69], v6, s[56:59], s60 offen
  v_add_f32 v96, v96, v112
  v_add_f32 v97, v97, v113
  v_add_f32 v98, v98, v114
  v_add_f32 v99, v99, v115
  v_add_f32 v100, v100, v116
  v_add_f32 v101, v101, v117
  v_add_f32 v102, v102, v118
  v_add_f32 v103, v103, v119
  v_add_f32 v104, v104, v120
  v_add_f32 v105, v105, v121
  v_add_f32 v106, v106, v122
  v_add_f32 v107, v107, v123
  v_add_f32 v108, v108, v124
  v_add_f32 v109, v109, v125
  v_add_f32 v110, v110, v126
  v_add_f32 v111, v111, v127
  v_add_f32 v96, v96, v104
  v_add_f32 v97, v97, v105
  v_add_f32 v98, v98, v106
  v_add_f32 v99, v99, v107
  v_add_f32 v100, v100, v108
  v_add_f32 v101, v101, v109
  v_add_f32 v102, v102, v110
  v_add_f32 v103, v103, v111
  v_add_f32 v96, v96, v100
  v_add_f32 v97, v97, v101
  v_add_f32 v98, v98, v102
  v_add_f32 v99, v99, v103
  v_cvt_pk_bf16_f32 v100, v96, v97
  v_cvt_pk_bf16_f32 v101, v98, v99
  v_lshlrev_b32 v96, 16, v100
  v_and_b32 v97, 0xffff0000, v100
  v_lshlrev_b32 v104, 16, v12
  v_and_b32 v105, 0xffff0000, v12
  v_lshlrev_b32 v98, 16, v101
  v_and_b32 v99, 0xffff0000, v101
  v_lshlrev_b32 v106, 16, v13
  v_and_b32 v107, 0xffff0000, v13
  v_add_f32 v96, v96, v104
  v_add_f32 v97, v97, v105
  v_add_f32 v98, v98, v106
  v_add_f32 v99, v99, v107
  v_cvt_pk_bf16_f32 v100, v96, v97
  v_cvt_pk_bf16_f32 v101, v98, v99
  buffer_store_dwordx2 v[100:101], v6, s[56:59], s61 offen
KEND:
  s_endpgm
.section .rodata,"a"
.p2align 6
.amdhsa_kernel sequential_preLN__ssm_conv_s4d__glu_gated_reglu__prompt_kernel
  .amdhsa_next_free_vgpr 256
  .amdhsa_next_free_sgpr 100
  .amdhsa_accum_offset 128
  .amdhsa_group_segment_fixed_size 0
  .amdhsa_kernarg_size 112
  .amdhsa_user_sgpr_count 2
  .amdhsa_user_sgpr_kernarg_segment_ptr 1
  .amdhsa_system_sgpr_workgroup_id_x 1
.end_amdhsa_kernel
.text
```
